```python
import torch

def _softmax(x, axis=-1):
    return torch.softmax(x, dim=axis)
def _gelu(x):
    return torch.nn.functional.gelu(x, approximate="tanh")
def _silu(x):
    return torch.nn.functional.silu(x)
def _sigmoid(x):
    return torch.sigmoid(x)
def _layernorm(x, axis=-1, eps=1e-5):
    m = x.mean(dim=axis, keepdim=True)
    v = x.var(dim=axis, keepdim=True, unbiased=False)
    return (x - m) / torch.sqrt(v + eps)
def _scatter_add(tgt, idx, src, axis=0):
    return tgt.clone().index_add_(axis, idx, src)
def _segment_sum(src, seg, n):
    out = torch.zeros((n,) + src.shape[1:], dtype=src.dtype)
    return out.index_add_(0, seg, src)
def _pad(x, pw):
    flat = tuple(v for pair in reversed(pw) for v in pair)
    return torch.nn.functional.pad(x, flat)

kernel_name = 'gated_mix__mha_block__ssm_conv_s4d__prompt'

def setup_inputs():

    _w = (lambda a: (lambda t: t.to(torch.bfloat16) if t.is_floating_point() else t)(torch.as_tensor(a)))
    def _A_setup():
        B, S, D, H = 1, 2048, 448, 16
        return {
            "x": _w((lambda *s: torch.randn(*s, dtype=torch.bfloat16) * 0.05)(B, S, D)),
            "wqkv": _w((lambda *s: torch.randn(*s, dtype=torch.bfloat16) * 0.8)(D, 3 * D)),
            "wo": _w((lambda *s: torch.randn(*s, dtype=torch.bfloat16) * 0.05)(D, D)),
        }
    _A_in = _A_setup()

    def _B_setup():
        Bsz, L, D, N = 1, 2048, 448, 256
        return {
            "u": _w((lambda *s: torch.randn(*s, dtype=torch.bfloat16) * 0.05)(Bsz, L, D)),
            "log_A_real": _w((lambda *s: torch.randn(*s, dtype=torch.bfloat16) * 3.2)(D, N) * 0.5),
            "A_imag": _w((lambda *s: torch.randn(*s, dtype=torch.bfloat16) * 0.05)(D, N) * 3.14),
            "C_real": _w((lambda *s: torch.randn(*s, dtype=torch.bfloat16) * 0.8)(D, N) / N ** 0.5),
            "C_imag": _w((lambda *s: torch.randn(*s, dtype=torch.bfloat16) * 0.8)(D, N) / N ** 0.5),
            "log_dt": _w((lambda *s: torch.randn(*s, dtype=torch.bfloat16) * 0.05)(D) * 0.5 - 4.0),
            "D_skip": _w((lambda *s: torch.randn(*s, dtype=torch.bfloat16) * 0.1)(D)),
        }
    _B_in = _B_setup()

    return {
        "A_x": _A_in["x"],
        "A_wqkv": _A_in["wqkv"],
        "A_wo": _A_in["wo"],
        "B_u": _B_in["u"],
        "B_log_A_real": _B_in["log_A_real"],
        "B_A_imag": _B_in["A_imag"],
        "B_C_real": _B_in["C_real"],
        "B_C_imag": _B_in["C_imag"],
        "B_log_dt": _B_in["log_dt"],
        "B_D_skip": _B_in["D_skip"],
        "gate_w": _w((lambda *s: torch.randn(*s, dtype=torch.bfloat16) * 0.05)(448) * 16.0),
    }

def reference(A_x, A_wqkv, A_wo, B_u, B_log_A_real, B_A_imag, B_C_real, B_C_imag, B_log_dt, B_D_skip, gate_w):
    def _A_ref(x, wqkv, wo):
        B, S, D = x.shape
        H = 16
        Dh = D // H
        qkv = (lambda x, *d: x.permute(*d))((x @ wqkv).reshape(B, S, 3, H, Dh), 2, 0, 3, 1, 4)
        q, k, v = qkv[0], qkv[1], qkv[2]
        scores = torch.einsum("bhqd,bhkd->bhqk", q, k) * (Dh ** -0.5)
        p = _softmax(scores, axis=-1)
        o = torch.einsum("bhqk,bhkd->bhqd", p, v)
        return (lambda x, *d: x.permute(*d))(o, 0, 2, 1, 3).reshape(B, S, D) @ wo

    def _B_ref(u, log_A_real, A_imag, C_real, C_imag, log_dt, D_skip):
        L = u.shape[1]
        dt = torch.exp(log_dt)
        A = -torch.exp(log_A_real) + 1j * A_imag
        C = (C_real + 1j * C_imag) * dt[:, None]
        pos = (lambda x, dt: x.to(dt))(torch.arange(L), log_dt.dtype)
        P = torch.exp((A * dt[:, None])[:, :, None] * pos[None, None, :])
        K = 2.0 * torch.einsum("dn,dnl->dl", C, P).real
        L2 = 2 * L
        u_t = (lambda x, *d: x.permute(*d))(u, 0, 2, 1)
        Kf = (lambda x, *a, **k: torch.fft.rfft(x.float(), *a, **k))(K, L2)
        Uf = (lambda x, *a, **k: torch.fft.rfft(x.float(), *a, **k))(u_t, L2)
        y = (lambda x, *a, **k: torch.fft.irfft(x, *a, **k).to(torch.bfloat16))(Uf * Kf[None, :, :], L2)[:, :, :L]
        y = (lambda x, *d: x.permute(*d))(y, 0, 2, 1)
        return y + u * D_skip[None, None, :]

    x = A_x
    g = _sigmoid((x * gate_w).sum(-1, keepdims=True))
    a = _A_ref(x, A_wqkv, A_wo)
    b = _B_ref(x, B_log_A_real, B_A_imag, B_C_real, B_C_imag, B_log_dt, B_D_skip)
    return g * a + (1 - g) * b
```

```asm
; @launch grid=(256,1,1) block=(512,1,1) lds=158144
.amdgcn_target "amdgcn-amd-amdhsa--gfx950"
.text
.globl gated_mix__mha_block__ssm_conv_s4d__prompt_kernel
.p2align 8
.type gated_mix__mha_block__ssm_conv_s4d__prompt_kernel,@function
gated_mix__mha_block__ssm_conv_s4d__prompt_kernel:
    s_getpc_b64 s[48:49]
L_pc:
    s_lshr_b32 s41, s2, 3
    v_lshrrev_b32 v1, 5, v0
    v_lshl_add_u32 v1, s41, 4, v1
    v_lshlrev_b32 v1, 7, v1
    v_cmp_gt_u32 vcc, L_slow-L_pc, v1
    s_load_dwordx8 s[8:15], s[0:1], 32
    s_load_dwordx4 s[4:7], s[0:1], 0
    s_mov_b64 exec, vcc
    global_load_dword v251, v1, s[48:49]
    s_mov_b64 exec, -1
    v_readfirstlane_b32 s24, v0
    s_cmp_ge_u32 s2, 256
    s_cbranch_scc1 L_quit0
    s_cmp_ge_u32 s24, 256
    s_cbranch_scc0 L_g0
    s_load_dwordx4 s[16:19], s[0:1], 64
    s_load_dwordx2 s[22:23], s[0:1], 104
    s_load_dwordx4 s[96:99], s[0:1], 88
    s_load_dwordx2 s[100:101], s[0:1], 16
    s_setprio 3
    s_and_b32 s40, s2, 7
    s_mul_i32 s40, s40, 28
    s_min_u32 s41, s41, 27
    s_add_u32 s27, s40, s41
    s_lshl_b32 s42, s27, 2
    s_lshl_b32 s40, s27, 10
    s_sub_u32 s40, s40, 1024
    v_lshl_add_u32 v1, v0, 2, s40
    v_and_b32 v0, 63, v0
    s_lshr_b32 s24, s24, 6
    s_and_b32 s50, s24, 3
    v_mov_b32 v7, 0
    s_cmp_eq_u32 s2, 248
    s_waitcnt lgkmcnt(0)
    s_cbranch_scc1 L_zero
L_nozero_h:
    global_load_dword v8, v1, s[8:9]
    global_load_dword v9, v1, s[10:11]
    global_load_dword v10, v1, s[12:13]
    global_load_dword v11, v1, s[14:15]
    s_load_dword s51, s[16:17], s42
    s_load_dword s52, s[18:19], s42
    s_setprio 0
    s_branch L_h1
L_g0:
    s_and_b32 s40, s2, 7
    s_lshr_b32 s41, s2, 3
    s_mul_i32 s40, s40, 31
    s_add_u32 s40, s40, s41
    s_cmp_ge_u32 s41, 31
    s_cselect_b32 s40, 242, s40
    s_min_u32 s40, s40, 242
    s_mov_b32 s42, 205
    s_cmp_lt_u32 s40, 110
    s_cselect_b32 s41, 0, 110
    s_cselect_b32 s42, s42, 171
    s_cselect_b32 s43, 5, 6
    s_cselect_b32 s26, 0, 5
    s_sub_u32 s40, s40, s41
    s_mul_i32 s25, s40, s42
    s_lshr_b32 s25, s25, 10
    s_mul_i32 s41, s25, s43
    s_sub_u32 s40, s40, s41
    s_add_u32 s26, s26, s40
    s_add_u32 s46, s25, s26
    s_mul_i32 s40, s46, 37
    s_lshr_b32 s40, s40, 8
    s_mul_i32 s40, s40, 7
    s_sub_u32 s46, s46, s40
    s_lshl_b32 s45, s24, 4
    v_lshrrev_b32 v4, 4, v0
    v_lshlrev_b32 v5, 2, v4
    v_xor_b32 v5, v5, v0
    v_and_b32 v5, 15, v5
    v_mul_u32_u24 v229, 2688, v4
    v_lshl_add_u32 v229, v5, 4, v229
    s_lshl_b32 s42, s26, 8
    s_sub_u32 s34, 1204224, s42
    s_mul_i32 s43, s25, 86016
    s_sub_u32 s30, 1835008, s43
    s_cselect_b32 s30, 0, s30
    s_cselect_b32 s34, 0, s34
    s_mov_b32 s35, 0x20000
    s_mul_i32 s58, s46, 172032
    s_add_u32 m0, s45, 103808
    s_waitcnt lgkmcnt(0)
    s_add_u32 s32, s6, s42
    s_addc_u32 s33, s7, 0
    buffer_load_dwordx4 v229, s[32:35], s58 offen lds
    v_xor_b32 v5, v4, v0
    v_and_b32 v5, 7, v5
    v_lshrrev_b32 v4, 3, v0
    v_mul_u32_u24 v252, 896, v4
    v_lshl_add_u32 v252, v5, 4, v252
    s_add_u32 s28, s4, s43
    s_addc_u32 s29, s5, 0
    s_mov_b32 s31, 0x20000
    s_lshl_b32 s59, s46, 7
    s_load_dwordx2 s[20:21], s[0:1], 80
    s_load_dwordx2 s[22:23], s[0:1], 104
    s_load_dwordx4 s[96:99], s[0:1], 88
    s_load_dwordx2 s[100:101], s[0:1], 16
    s_add_u32 m0, s45, 120192
    s_add_u32 s41, s59, 0
    buffer_load_dwordx4 v252, s[28:31], s41 offen lds
    s_add_u32 m0, s45, 107904
    s_add_u32 s40, s58, 43008
    buffer_load_dwordx4 v229, s[32:35], s40 offen lds
    s_add_u32 m0, s45, 124288
    s_add_u32 s41, s59, 28672
    buffer_load_dwordx4 v252, s[28:31], s41 offen lds
    s_add_u32 m0, s45, 112000
    s_add_u32 s40, s58, 86016
    buffer_load_dwordx4 v229, s[32:35], s40 offen lds
    s_add_u32 m0, s45, 128384
    s_add_u32 s41, s59, 57344
    buffer_load_dwordx4 v252, s[28:31], s41 offen lds
    s_add_u32 m0, s45, 116096
    s_add_u32 s40, s58, 129024
    buffer_load_dwordx4 v229, s[32:35], s40 offen lds
    v_and_b32 v0, 63, v0
    s_lshr_b32 s24, s24, 6
    s_mov_b32 s50, s24
    s_mov_b32 s57, s46
    s_mov_b32 s38, 896
    s_mov_b32 s39, 0x20000
    s_mov_b32 m0, 157056
    v_lshlrev_b32 v4, 4, v0
    s_cmp_eq_u32 s2, 248
    s_waitcnt lgkmcnt(0)
    s_mov_b32 s36, s20
    s_mov_b32 s37, s21
    buffer_load_dwordx4 v4, s[36:39], 0 offen lds
    s_cbranch_scc0 L_g1
    s_barrier
    s_branch L_g1
L_zero:
    s_add_u32 s60, s22, 17825792
    s_addc_u32 s61, s23, 0
    s_mul_i32 s40, s50, 8192
    v_lshrrev_b32 v4, 1, v0
    v_lshl_add_u32 v4, v4, 8, s40
    v_and_b32 v5, 1, v0
    v_lshl_add_u32 v4, v5, 4, v4
    v_mov_b32 v20, 0
    v_mov_b32 v21, 0
    v_mov_b32 v22, 0
    v_mov_b32 v23, 0
    global_store_dwordx4 v4, v[20:23], s[60:61] sc0 sc1
    s_lshl_b32 s40, s50, 4
    v_add_u32 v4, s40, v0
    v_mul_u32_u24 v4, 28672, v4
    v_add_u32 v4, 8388608, v4
    v_mov_b32 v16, 0x3f803f80
    v_mov_b32 v17, v16
    v_mov_b32 v18, v16
    v_mov_b32 v19, v16
    s_mov_b64 exec, 0xffff
    global_store_dwordx4 v4, v[16:19], s[22:23] sc0 sc1
    s_mov_b64 exec, -1
    v_mov_b32 v21, 1
    s_waitcnt vmcnt(0)
    s_barrier
    s_cmp_lg_u32 s24, 4
    s_cbranch_scc1 L_nozero_h
    s_mov_b64 exec, 1
    global_store_dword v20, v21, s[98:99] sc0 sc1
    s_mov_b64 exec, -1
    s_waitcnt vmcnt(0)
    s_branch L_nozero_h
L_g1:
    s_setprio 2
    s_add_u32 s60, s22, 17825792
    s_addc_u32 s61, s23, 0
    v_mov_b32 v4, 0
    v_mov_b32 v5, 0
    v_lshlrev_b32 v6, 3, v0
    v_and_b32 v6, 63, v6
    v_add_u32 v6, 158080, v6
    ds_write_b64 v6, v[4:5]
    v_lshlrev_b32 v231, 4, v0
    s_lshl_b32 s53, s26, 2
    s_add_u32 s53, s53, s24
    v_and_b32 v1, 31, v0
    v_lshrrev_b32 v2, 5, v0
    v_lshrrev_b32 v3, 1, v0
    v_and_b32 v3, 7, v3
    v_xor_b32 v3, v3, v2
    v_lshlrev_b32 v10, 7, v1
    v_lshl_add_u32 v10, v3, 4, v10
    v_xor_b32 v11, 32, v10
    v_xor_b32 v12, 64, v10
    v_xor_b32 v13, 96, v10
    v_mov_b32 v239, 1
    s_mul_i32 s42, s53, 37
    s_lshr_b32 s42, s42, 9
    s_mul_i32 s41, s42, 14
    s_sub_u32 s52, s53, s41
    s_lshl_b32 s42, s42, 21
    s_add_u32 s4, s22, s42
    s_addc_u32 s5, s23, 0
    s_mov_b32 s6, 1835008
    s_mov_b32 s7, 0x20000
    v_bfe_u32 v16, v0, 4, 1
    v_bfe_u32 v4, v0, 2, 2
    v_lshl_add_u32 v17, v2, 3, v4
    v_lshlrev_b32 v8, 8, v17
    v_xor_b32 v17, s24, v4
    v_lshl_add_u32 v8, v17, 6, v8
    v_lshl_add_u32 v8, v16, 5, v8
    v_add_u32 v8, 103808, v8
    v_and_b32 v17, 3, v0
    v_add_u32 v3, 120192, v10
    v_add_u32 v4, 120192, v11
    v_add_u32 v5, 120192, v12
    v_add_u32 v15, 120192, v13
    v_add_u32 v10, 107904, v10
    v_add_u32 v11, 107904, v11
    v_add_u32 v12, 107904, v12
    v_add_u32 v13, 107904, v13
    s_add_u32 s59, s57, 1
    s_sub_u32 s58, s59, 7
    s_min_u32 s59, s59, s58
    s_mul_i32 s58, s59, 172032
    s_lshl_b32 s59, s59, 7
    s_add_u32 m0, s45, 132480
    s_add_u32 s40, s58, 0
    buffer_load_dwordx4 v229, s[32:35], s40 offen lds
    s_add_u32 m0, s45, 148864
    s_add_u32 s41, s59, 0
    buffer_load_dwordx4 v252, s[28:31], s41 offen lds
    s_add_u32 m0, s45, 136576
    s_add_u32 s40, s58, 43008
    buffer_load_dwordx4 v229, s[32:35], s40 offen lds
    s_add_u32 m0, s45, 140672
    s_add_u32 s40, s58, 86016
    buffer_load_dwordx4 v229, s[32:35], s40 offen lds
    s_add_u32 m0, s45, 144768
    s_add_u32 s40, s58, 129024
    buffer_load_dwordx4 v229, s[32:35], s40 offen lds
    s_mul_i32 s56, s25, 205
    s_lshr_b32 s56, s56, 10
    s_mul_i32 s40, s56, 5
    s_sub_u32 s40, s25, s40
    s_lshl_b32 s41, s56, 4
    s_add_u32 s41, s41, s40
    s_add_u32 s92, s41, s40
    s_add_u32 s93, s92, 1
    s_add_u32 s95, s41, 10
    s_cmp_eq_u32 s25, 20
    s_cselect_b32 s92, 15, s92
    s_cselect_b32 s93, 31, s93
    s_cselect_b32 s95, 47, s95
    s_cmp_eq_u32 s25, 21
    s_cselect_b32 s92, 63, s92
    s_mul_i32 s40, s25, 3
    s_add_u32 s41, s40, 1
    s_add_u32 s94, s40, 2
    s_sub_u32 s42, s53, 14
    s_cmp_lt_u32 s42, 28
    s_cselect_b32 s92, s92, s40
    s_cselect_b32 s93, s93, s41
    s_cselect_b32 s94, 64, s94
    s_cselect_b32 s95, s95, 64
    s_mul_i32 s92, s92, 28672
    s_mul_i32 s93, s93, 28672
    s_mul_i32 s94, s94, 28672
    s_mul_i32 s95, s95, 28672
    s_mul_i32 s40, s25, 3
    s_add_u32 s41, s40, 2
    s_min_u32 s41, s41, 63
    s_cmp_lt_u32 s53, 14
    s_cselect_b32 s42, 2, 4
    s_lshr_b32 s40, s40, s42
    s_lshr_b32 s41, s41, s42
    s_cmp_eq_u32 s40, s41
    s_cselect_b32 s54, 3, 15
    s_mov_b32 s55, 0
    s_mov_b32 s49, 0
    s_mul_i32 s51, s40, 14
    s_mul_i32 s41, s52, 1176
    s_lshr_b32 s41, s41, 10
    v_and_b32 v18, 1, v0
    v_add_u32 v18, s41, v18
    v_bfe_u32 v19, v0, 1, 2
    s_cmp_eq_u32 s25, 20
    s_cselect_b32 s48, 63, 3
    s_cselect_b32 s42, 0, s56
    s_min_u32 s42, s42, 3
    v_lshl_add_u32 v20, v18, 2, s42
    v_add_u32 v20, v20, v19
    v_lshlrev_b32 v20, 8, v20
    v_add_u32 v238, 16, v20
    s_sub_u32 s42, s53, 14
    s_cmp_lt_u32 s42, 28
    s_cselect_b32 s43, 1, 0
    s_cmp_lt_u32 s25, 22
    s_cselect_b32 s43, s43, 0
    s_cselect_b32 s54, s54, 0
    v_mov_b32 v253, s43
    s_cmp_lt_u32 s42, 28
    s_cbranch_scc0 L_cnt_q
    v_mov_b32 v254, v20
    s_cmp_lt_u32 s25, 20
    s_cselect_b32 s54, 3, 0
    s_branch L_cnt_done
L_cnt_q:
    s_mov_b32 s48, 1
    v_lshlrev_b32 v18, 4, v18
    v_add3_u32 v18, v18, v19, s40
    v_and_b32 v19, 63, v18
    v_lshrrev_b32 v18, 6, v18
    v_lshlrev_b32 v19, 8, v19
    v_add_u32 v19, 16384, v19
    v_lshl_add_u32 v254, v18, 2, v19
    s_cmp_lt_u32 s53, 42
    s_cbranch_scc1 L_cnt_done
    v_add_u32 v20, s51, v0
    v_lshl_add_u32 v254, v20, 8, 8
    s_mov_b32 s40, 0x3fff
    s_cmp_eq_u32 s54, 3
    s_cselect_b32 s54, s40, 0xfffffff
    s_cmp_eq_u32 s53, 42
    s_cselect_b32 s54, s54, 0
L_cnt_done:
    s_cmp_ge_u32 s2, 248
    s_cbranch_scc1 L_womall
L_womall_back:
    s_add_u32 s59, s57, 2
    s_sub_u32 s58, s59, 7
    s_min_u32 s59, s59, s58
    s_mul_i32 s58, s59, 172032
    s_lshl_b32 s59, s59, 7
    s_add_u32 m0, s45, 83328
    s_add_u32 s40, s58, 0
    buffer_load_dwordx4 v229, s[32:35], s40 offen lds
    s_add_u32 m0, s45, 99712
    s_add_u32 s41, s59, 0
    buffer_load_dwordx4 v252, s[28:31], s41 offen lds
    s_add_u32 m0, s45, 87424
    s_add_u32 s40, s58, 43008
    buffer_load_dwordx4 v229, s[32:35], s40 offen lds
    s_add_u32 m0, s45, 91520
    s_add_u32 s40, s58, 86016
    buffer_load_dwordx4 v229, s[32:35], s40 offen lds
    s_add_u32 m0, s45, 95616
    s_add_u32 s40, s58, 129024
    buffer_load_dwordx4 v229, s[32:35], s40 offen lds
    s_cmp_ge_u32 s53, 42
    s_cbranch_scc1 L_gate
    s_cmp_ge_u32 s53, 28
    s_cbranch_scc1 L_v
    s_branch L_qk
L_h1:
    s_and_b32 s40, s2, 7
    s_lshr_b32 s41, s2, 3
    s_mul_i32 s40, s40, 31
    s_add_u32 s40, s40, s41
    s_cmp_ge_u32 s41, 31
    s_cselect_b32 s40, 242, s40
    s_min_u32 s40, s40, 242
    s_mov_b32 s42, 205
    s_cmp_lt_u32 s40, 110
    s_cselect_b32 s41, 0, 110
    s_cselect_b32 s42, s42, 171
    s_cselect_b32 s43, 5, 6
    s_cselect_b32 s26, 0, 5
    s_sub_u32 s40, s40, s41
    s_mul_i32 s25, s40, s42
    s_lshr_b32 s25, s25, 10
    s_mul_i32 s41, s25, s43
    s_sub_u32 s40, s40, s41
    s_add_u32 s26, s26, s40
    s_add_u32 s46, s25, s26
    s_mul_i32 s40, s46, 37
    s_lshr_b32 s40, s40, 8
    s_mul_i32 s40, s40, 7
    s_sub_u32 s46, s46, s40
    s_lshl_b32 s45, s50, 10
    v_lshrrev_b32 v4, 3, v0
    s_lshl_b32 s41, s50, 3
    v_add_u32 v4, s41, v4
    v_lshrrev_b32 v5, 1, v4
    v_xor_b32 v5, v5, v0
    v_and_b32 v5, 7, v5
    v_mul_u32_u24 v2, 896, v4
    v_lshl_add_u32 v2, v5, 4, v2
    s_mov_b32 s57, s46
    s_mul_i32 s58, s25, 86016
    s_sub_u32 s30, 1835008, s58
    s_cselect_b32 s30, 0, s30
    s_mov_b32 s31, 0x20000
    s_mov_b32 s35, 0x20000
    s_add_u32 s28, s4, s58
    s_addc_u32 s29, s5, 0
    v_lshrrev_b32 v4, 4, v0
    v_lshlrev_b32 v5, 2, v4
    v_xor_b32 v5, v5, v0
    v_and_b32 v5, 15, v5
    s_lshl_b32 s41, s50, 2
    v_add_u32 v4, s41, v4
    v_mul_u32_u24 v3, 2688, v4
    v_lshl_add_u32 v3, v5, 4, v3
    s_lshl_b32 s59, s26, 8
    s_sub_u32 s34, 1204224, s59
    s_cmp_ge_u32 s25, 22
    s_cselect_b32 s34, 0, s34
    s_add_u32 s32, s6, s59
    s_addc_u32 s33, s7, 0
    s_add_u32 s60, s22, 17825792
    s_addc_u32 s61, s23, 0
L_helper:
    s_mov_b32 s36, s22
    s_mov_b32 s37, s23
    s_mov_b32 s38, 18874368
    s_mov_b32 s39, 0x20000
    s_mul_i32 s18, s50, 8704
    v_and_b32 v4, 31, v0
    v_lshrrev_b32 v5, 5, v0
    v_mul_u32_u24 v24, 272, v4
    v_lshl_add_u32 v24, v5, 4, v24
    v_add_u32 v24, s18, v24
    s_lshr_b32 s47, s50, 1
    s_mul_i32 s40, s50, 3072
    s_add_u32 s40, s40, 34816
    v_lshl_add_u32 v25, v0, 4, s40
    s_lshl_b32 s40, s50, 2
    s_add_u32 s40, s40, 158128
    v_mov_b32 v255, s40
    v_mov_b32 v23, 158080
    v_and_b32 v14, 15, v0
    v_lshrrev_b32 v15, 5, v0
    s_lshl_b32 s40, s50, 1
    v_add_u32 v15, s40, v15
    v_lshrrev_b32 v78, 1, v14
    v_xor_b32 v15, v15, v78
    v_lshlrev_b32 v78, 7, v14
    v_lshl_add_u32 v78, v15, 4, v78
    v_bfe_u32 v15, v0, 4, 1
    v_lshl_add_u32 v78, v15, 3, v78
    v_add_u32 v78, 120192, v78
    s_mul_i32 s40, s25, 86016
    s_lshl_b32 s41, s46, 12
    s_add_u32 s41, s41, s45
    s_add_u32 s41, s41, s40
    v_lshl_add_u32 v79, v0, 4, s41
    s_add_u32 s92, s22, 6291456
    s_addc_u32 s93, s23, 0
    s_sub_u32 s40, s26, 2
    s_cmp_lt_u32 s40, 7
    s_cselect_b32 s94, 1835008, 0
    s_mov_b32 s95, 0x20000
    s_cselect_b32 s48, 1, 0
    s_cmp_ge_u32 s25, 22
    s_cselect_b32 s48, 0, s48
    s_mov_b32 s54, 28672
    s_mov_b32 s55, 57344
    s_lshl_b32 s40, s46, 2
    s_add_u32 s40, s40, s50
    s_lshl_b32 s40, s40, 8
    s_add_u32 s40, s40, 12
    v_mov_b32 v92, s40
    v_mov_b32 v93, s48
    s_lshr_b32 s40, s27, 3
    s_lshl_b32 s40, s40, 8
    s_add_u32 s40, s40, 12
    v_mov_b32 v20, s40
    v_lshrrev_b32 v14, 2, v0
    v_mul_u32_u24 v14, 28672, v14
    v_and_b32 v15, 3, v0
    v_lshl_add_u32 v19, v15, 6, v14
    s_lshr_b32 s14, s27, 1
    s_lshl_b32 s14, s14, 8
    s_and_b32 s15, s27, 1
    s_lshl_b32 s15, s15, 1
    s_add_u32 s15, s15, s47
    s_lshl_b32 s15, s15, 4
    s_add_u32 s14, s14, s15
    s_and_b32 s16, s50, 1
    s_mul_i32 s15, s16, 917504
    s_add_u32 s14, s14, s15
    s_add_u32 s14, s14, 6291456
    s_add_u32 s15, s14, 458752
    s_mul_i32 s17, s47, 4608
    s_add_u32 s13, s17, 74112
    s_lshl_b32 s16, s16, 11
    s_add_u32 s17, s17, s16
    s_mul_i32 s19, s47, 4160
    s_add_u32 s19, s19, 65792
    s_add_u32 s40, s19, 64
    v_lshl_add_u32 v18, v0, 4, s40
    v_lshl_add_u32 v254, v4, 4, s40
    v_lshl_add_u32 v254, v5, 3, v254
    v_bfe_u32 v14, v0, 4, 2
    v_lshlrev_b32 v16, 5, v14
    v_lshl_add_u32 v16, v15, 3, v16
    v_bfe_u32 v14, v0, 2, 2
    v_lshlrev_b32 v14, 3, v14
    v_sub_u32 v16, v16, v14
    s_add_u32 s40, s19, 32
    v_add_u32 v16, s40, v16
    v_lshlrev_b32 v14, 4, v4
    v_lshlrev_b32 v15, 6, v5
    v_sub_u32 v14, v14, v15
    s_add_u32 s40, s13, 128
    v_add_u32 v17, s40, v14
    s_lshl_b32 s40, s50, 11
    v_lshl_add_u32 v21, v0, 4, s40
    s_lshl_b32 s12, s27, 13
    s_add_u32 s12, s12, 14680064
    s_lshr_b32 s41, s27, 4
    s_mul_i32 s40, s50, 14
    s_add_u32 s40, s40, s41
    s_lshl_b32 s40, s40, 8
    s_add_u32 s40, s40, 8
    v_mov_b32 v22, s40
    s_waitcnt lgkmcnt(0)
    s_lshl_b32 s41, s51, 16
    s_and_b32 s51, s51, 0xffff0000
    s_lshl_b32 s42, s52, 16
    s_and_b32 s52, s52, 0xffff0000
    s_cmp_ge_u32 s50, 2
    s_cselect_b32 s51, s51, s41
    s_cselect_b32 s44, s52, s42
    v_mov_b32 v12, s51
    v_mul_f32 v12, 0x3fb8aa3b, v12
    v_exp_f32 v12, v12
    s_nop 0
    v_cvt_pk_bf16_f32 v12, v12, v12
    v_and_b32 v12, 0xffff0000, v12
    v_add_f32 v13, v12, v12
    s_waitcnt vmcnt(0)
    v_lshlrev_b32 v36, 16, v8
    v_lshlrev_b32 v37, 16, v9
    v_mul_f32 v36, 0x3fb8aa3b, v36
    v_lshlrev_b32 v34, 16, v10
    v_exp_f32 v36, v36
    v_lshlrev_b32 v35, 16, v11
    v_mul_f32 v37, v37, v12
    v_cvt_pk_bf16_f32 v36, v36, v36
    v_mul_f32 v37, 0x3e22f983, v37
    v_and_b32 v36, 0xffff0000, v36
    v_mul_f32 v34, v34, v13
    v_mul_f32 v36, v36, v12
    v_mul_f32 v35, v35, v13
    v_mul_f32 v36, 0xbfb8aa3b, v36
    v_mul_f32 v38, 0x41000000, v37
    v_mul_f32 v39, 0x43800000, v37
    v_mul_f32 v40, 0x41000000, v36
    v_mul_f32 v41, 0x43800000, v36
    v_fract_f32 v38, v38
    v_fract_f32 v39, v39
    v_fract_f32 v37, v37
    v_exp_f32 v40, v40
    v_cos_f32 v28, v38
    v_sin_f32 v29, v38
    v_exp_f32 v36, v36
    v_mul_f32 v28, v28, v40
    v_mul_f32 v29, v29, v40
    v_cos_f32 v26, v37
    v_sin_f32 v27, v37
    v_exp_f32 v41, v41
    v_mul_f32 v26, v26, v36
    v_mul_f32 v27, v27, v36
    v_cos_f32 v30, v39
    v_sin_f32 v31, v39
    v_mul_f32 v32, v29, v29
    v_mul_f32 v33, v28, v29
    v_mul_f32 v30, v30, v41
    v_mul_f32 v31, v31, v41
    v_fma_f32 v32, v28, v28, -v32
    v_add_f32 v33, v33, v33
    v_mov_b32 v148, 0x3f80
    v_cvt_pk_bf16_f32 v149, v28, v29
    v_pk_mul_f32 v[42:43], v[28:29], v[32:33] op_sel:[0,0] op_sel_hi:[1,0]
    v_pk_fma_f32 v[46:47], v[28:29], v[32:33], v[42:43] op_sel:[1,1,0] op_sel_hi:[0,1,1] neg_lo:[1,0,0]
    v_cvt_pk_bf16_f32 v150, v32, v33
    v_cvt_pk_bf16_f32 v151, v46, v47
    v_pk_mul_f32 v[42:43], v[46:47], v[32:33] op_sel:[0,0] op_sel_hi:[1,0]
    v_pk_mul_f32 v[52:53], v[32:33], v[32:33] op_sel:[0,0] op_sel_hi:[1,0]
    v_pk_fma_f32 v[46:47], v[46:47], v[32:33], v[42:43] op_sel:[1,1,0] op_sel_hi:[0,1,1] neg_lo:[1,0,0]
    v_pk_fma_f32 v[44:45], v[32:33], v[32:33], v[52:53] op_sel:[1,1,0] op_sel_hi:[0,1,1] neg_lo:[1,0,0]
    v_cvt_pk_bf16_f32 v152, v44, v45
    v_cvt_pk_bf16_f32 v153, v46, v47
    v_pk_mul_f32 v[42:43], v[46:47], v[32:33] op_sel:[0,0] op_sel_hi:[1,0]
    v_pk_mul_f32 v[52:53], v[44:45], v[32:33] op_sel:[0,0] op_sel_hi:[1,0]
    v_pk_fma_f32 v[46:47], v[46:47], v[32:33], v[42:43] op_sel:[1,1,0] op_sel_hi:[0,1,1] neg_lo:[1,0,0]
    v_pk_fma_f32 v[44:45], v[44:45], v[32:33], v[52:53] op_sel:[1,1,0] op_sel_hi:[0,1,1] neg_lo:[1,0,0]
    v_cvt_pk_bf16_f32 v154, v44, v45
    v_cvt_pk_bf16_f32 v155, v46, v47
    v_pk_mul_f32 v[42:43], v[46:47], v[32:33] op_sel:[0,0] op_sel_hi:[1,0]
    v_pk_mul_f32 v[52:53], v[44:45], v[32:33] op_sel:[0,0] op_sel_hi:[1,0]
    v_pk_fma_f32 v[46:47], v[46:47], v[32:33], v[42:43] op_sel:[1,1,0] op_sel_hi:[0,1,1] neg_lo:[1,0,0]
    v_pk_fma_f32 v[44:45], v[44:45], v[32:33], v[52:53] op_sel:[1,1,0] op_sel_hi:[0,1,1] neg_lo:[1,0,0]
    v_cvt_pk_bf16_f32 v156, v44, v45
    v_cvt_pk_bf16_f32 v157, v46, v47
    v_pk_mul_f32 v[42:43], v[46:47], v[32:33] op_sel:[0,0] op_sel_hi:[1,0]
    v_pk_mul_f32 v[52:53], v[44:45], v[32:33] op_sel:[0,0] op_sel_hi:[1,0]
    v_pk_fma_f32 v[46:47], v[46:47], v[32:33], v[42:43] op_sel:[1,1,0] op_sel_hi:[0,1,1] neg_lo:[1,0,0]
    v_pk_fma_f32 v[44:45], v[44:45], v[32:33], v[52:53] op_sel:[1,1,0] op_sel_hi:[0,1,1] neg_lo:[1,0,0]
    v_cvt_pk_bf16_f32 v158, v44, v45
    v_cvt_pk_bf16_f32 v159, v46, v47
    v_pk_mul_f32 v[42:43], v[46:47], v[32:33] op_sel:[0,0] op_sel_hi:[1,0]
    v_pk_mul_f32 v[52:53], v[44:45], v[32:33] op_sel:[0,0] op_sel_hi:[1,0]
    v_pk_fma_f32 v[46:47], v[46:47], v[32:33], v[42:43] op_sel:[1,1,0] op_sel_hi:[0,1,1] neg_lo:[1,0,0]
    v_pk_fma_f32 v[44:45], v[44:45], v[32:33], v[52:53] op_sel:[1,1,0] op_sel_hi:[0,1,1] neg_lo:[1,0,0]
    v_cvt_pk_bf16_f32 v160, v44, v45
    v_cvt_pk_bf16_f32 v161, v46, v47
    v_pk_mul_f32 v[42:43], v[46:47], v[32:33] op_sel:[0,0] op_sel_hi:[1,0]
    v_pk_mul_f32 v[52:53], v[44:45], v[32:33] op_sel:[0,0] op_sel_hi:[1,0]
    v_pk_fma_f32 v[46:47], v[46:47], v[32:33], v[42:43] op_sel:[1,1,0] op_sel_hi:[0,1,1] neg_lo:[1,0,0]
    v_pk_fma_f32 v[44:45], v[44:45], v[32:33], v[52:53] op_sel:[1,1,0] op_sel_hi:[0,1,1] neg_lo:[1,0,0]
    v_cvt_pk_bf16_f32 v162, v44, v45
    v_cvt_pk_bf16_f32 v163, v46, v47
    v_pk_mul_f32 v[42:43], v[46:47], v[32:33] op_sel:[0,0] op_sel_hi:[1,0]
    v_pk_mul_f32 v[52:53], v[44:45], v[32:33] op_sel:[0,0] op_sel_hi:[1,0]
    v_pk_fma_f32 v[46:47], v[46:47], v[32:33], v[42:43] op_sel:[1,1,0] op_sel_hi:[0,1,1] neg_lo:[1,0,0]
    v_pk_fma_f32 v[44:45], v[44:45], v[32:33], v[52:53] op_sel:[1,1,0] op_sel_hi:[0,1,1] neg_lo:[1,0,0]
    v_cvt_pk_bf16_f32 v164, v44, v45
    v_cvt_pk_bf16_f32 v165, v46, v47
    v_pk_mul_f32 v[42:43], v[46:47], v[32:33] op_sel:[0,0] op_sel_hi:[1,0]
    v_pk_mul_f32 v[52:53], v[44:45], v[32:33] op_sel:[0,0] op_sel_hi:[1,0]
    v_pk_fma_f32 v[46:47], v[46:47], v[32:33], v[42:43] op_sel:[1,1,0] op_sel_hi:[0,1,1] neg_lo:[1,0,0]
    v_pk_fma_f32 v[44:45], v[44:45], v[32:33], v[52:53] op_sel:[1,1,0] op_sel_hi:[0,1,1] neg_lo:[1,0,0]
    v_cvt_pk_bf16_f32 v166, v44, v45
    v_cvt_pk_bf16_f32 v167, v46, v47
    v_pk_mul_f32 v[42:43], v[46:47], v[32:33] op_sel:[0,0] op_sel_hi:[1,0]
    v_pk_mul_f32 v[52:53], v[44:45], v[32:33] op_sel:[0,0] op_sel_hi:[1,0]
    v_pk_fma_f32 v[46:47], v[46:47], v[32:33], v[42:43] op_sel:[1,1,0] op_sel_hi:[0,1,1] neg_lo:[1,0,0]
    v_pk_fma_f32 v[44:45], v[44:45], v[32:33], v[52:53] op_sel:[1,1,0] op_sel_hi:[0,1,1] neg_lo:[1,0,0]
    v_cvt_pk_bf16_f32 v168, v44, v45
    v_cvt_pk_bf16_f32 v169, v46, v47
    v_pk_mul_f32 v[42:43], v[46:47], v[32:33] op_sel:[0,0] op_sel_hi:[1,0]
    v_pk_mul_f32 v[52:53], v[44:45], v[32:33] op_sel:[0,0] op_sel_hi:[1,0]
    v_pk_fma_f32 v[46:47], v[46:47], v[32:33], v[42:43] op_sel:[1,1,0] op_sel_hi:[0,1,1] neg_lo:[1,0,0]
    v_pk_fma_f32 v[44:45], v[44:45], v[32:33], v[52:53] op_sel:[1,1,0] op_sel_hi:[0,1,1] neg_lo:[1,0,0]
    v_cvt_pk_bf16_f32 v170, v44, v45
    v_cvt_pk_bf16_f32 v171, v46, v47
    v_pk_mul_f32 v[42:43], v[46:47], v[32:33] op_sel:[0,0] op_sel_hi:[1,0]
    v_pk_mul_f32 v[52:53], v[44:45], v[32:33] op_sel:[0,0] op_sel_hi:[1,0]
    v_pk_fma_f32 v[46:47], v[46:47], v[32:33], v[42:43] op_sel:[1,1,0] op_sel_hi:[0,1,1] neg_lo:[1,0,0]
    v_pk_fma_f32 v[44:45], v[44:45], v[32:33], v[52:53] op_sel:[1,1,0] op_sel_hi:[0,1,1] neg_lo:[1,0,0]
    v_cvt_pk_bf16_f32 v172, v44, v45
    v_cvt_pk_bf16_f32 v173, v46, v47
    v_pk_mul_f32 v[42:43], v[46:47], v[32:33] op_sel:[0,0] op_sel_hi:[1,0]
    v_pk_mul_f32 v[52:53], v[44:45], v[32:33] op_sel:[0,0] op_sel_hi:[1,0]
    v_pk_fma_f32 v[46:47], v[46:47], v[32:33], v[42:43] op_sel:[1,1,0] op_sel_hi:[0,1,1] neg_lo:[1,0,0]
    v_pk_fma_f32 v[44:45], v[44:45], v[32:33], v[52:53] op_sel:[1,1,0] op_sel_hi:[0,1,1] neg_lo:[1,0,0]
    v_cvt_pk_bf16_f32 v174, v44, v45
    v_cvt_pk_bf16_f32 v175, v46, v47
    v_pk_mul_f32 v[42:43], v[46:47], v[32:33] op_sel:[0,0] op_sel_hi:[1,0]
    v_pk_mul_f32 v[52:53], v[44:45], v[32:33] op_sel:[0,0] op_sel_hi:[1,0]
    v_pk_fma_f32 v[46:47], v[46:47], v[32:33], v[42:43] op_sel:[1,1,0] op_sel_hi:[0,1,1] neg_lo:[1,0,0]
    v_pk_fma_f32 v[44:45], v[44:45], v[32:33], v[52:53] op_sel:[1,1,0] op_sel_hi:[0,1,1] neg_lo:[1,0,0]
    v_cvt_pk_bf16_f32 v176, v44, v45
    v_cvt_pk_bf16_f32 v177, v46, v47
    v_pk_mul_f32 v[42:43], v[46:47], v[32:33] op_sel:[0,0] op_sel_hi:[1,0]
    v_pk_mul_f32 v[52:53], v[44:45], v[32:33] op_sel:[0,0] op_sel_hi:[1,0]
    v_pk_fma_f32 v[46:47], v[46:47], v[32:33], v[42:43] op_sel:[1,1,0] op_sel_hi:[0,1,1] neg_lo:[1,0,0]
    v_pk_fma_f32 v[44:45], v[44:45], v[32:33], v[52:53] op_sel:[1,1,0] op_sel_hi:[0,1,1] neg_lo:[1,0,0]
    v_cvt_pk_bf16_f32 v178, v44, v45
    v_cvt_pk_bf16_f32 v179, v46, v47
    v_cvt_pk_bf16_f32 v180, v34, -v35
    v_pk_mul_f32 v[42:43], v[34:35], v[26:27] op_sel:[0,0] op_sel_hi:[1,0]
    v_pk_mul_f32 v[52:53], v[34:35], v[30:31] op_sel:[0,0] op_sel_hi:[1,0]
    v_pk_fma_f32 v[60:61], v[34:35], v[26:27], v[42:43] op_sel:[1,1,0] op_sel_hi:[0,1,1] neg_lo:[1,0,0]
    v_pk_fma_f32 v[74:75], v[34:35], v[30:31], v[52:53] op_sel:[1,1,0] op_sel_hi:[0,1,1] neg_lo:[1,0,0]
    v_cvt_pk_bf16_f32 v181, v60, -v61
    v_cvt_pk_bf16_f32 v188, v74, -v75
    v_pk_mul_f32 v[42:43], v[60:61], v[26:27] op_sel:[0,0] op_sel_hi:[1,0]
    v_pk_mul_f32 v[52:53], v[74:75], v[30:31] op_sel:[0,0] op_sel_hi:[1,0]
    v_pk_fma_f32 v[62:63], v[60:61], v[26:27], v[42:43] op_sel:[1,1,0] op_sel_hi:[0,1,1] neg_lo:[1,0,0]
    v_pk_fma_f32 v[74:75], v[74:75], v[30:31], v[52:53] op_sel:[1,1,0] op_sel_hi:[0,1,1] neg_lo:[1,0,0]
    v_cvt_pk_bf16_f32 v182, v62, -v63
    v_cvt_pk_bf16_f32 v192, v74, -v75
    v_pk_mul_f32 v[42:43], v[62:63], v[26:27] op_sel:[0,0] op_sel_hi:[1,0]
    v_pk_mul_f32 v[52:53], v[74:75], v[30:31] op_sel:[0,0] op_sel_hi:[1,0]
    v_pk_fma_f32 v[64:65], v[62:63], v[26:27], v[42:43] op_sel:[1,1,0] op_sel_hi:[0,1,1] neg_lo:[1,0,0]
    v_pk_fma_f32 v[74:75], v[74:75], v[30:31], v[52:53] op_sel:[1,1,0] op_sel_hi:[0,1,1] neg_lo:[1,0,0]
    v_cvt_pk_bf16_f32 v183, v64, -v65
    v_cvt_pk_bf16_f32 v194, v74, -v75
    v_pk_mul_f32 v[42:43], v[64:65], v[26:27] op_sel:[0,0] op_sel_hi:[1,0]
    v_pk_mul_f32 v[52:53], v[74:75], v[30:31] op_sel:[0,0] op_sel_hi:[1,0]
    v_pk_fma_f32 v[66:67], v[64:65], v[26:27], v[42:43] op_sel:[1,1,0] op_sel_hi:[0,1,1] neg_lo:[1,0,0]
    v_pk_fma_f32 v[74:75], v[74:75], v[30:31], v[52:53] op_sel:[1,1,0] op_sel_hi:[0,1,1] neg_lo:[1,0,0]
    v_cvt_pk_bf16_f32 v184, v66, -v67
    v_cvt_pk_bf16_f32 v196, v74, -v75
    v_pk_mul_f32 v[42:43], v[66:67], v[26:27] op_sel:[0,0] op_sel_hi:[1,0]
    v_pk_mul_f32 v[52:53], v[74:75], v[30:31] op_sel:[0,0] op_sel_hi:[1,0]
    v_pk_fma_f32 v[68:69], v[66:67], v[26:27], v[42:43] op_sel:[1,1,0] op_sel_hi:[0,1,1] neg_lo:[1,0,0]
    v_pk_fma_f32 v[74:75], v[74:75], v[30:31], v[52:53] op_sel:[1,1,0] op_sel_hi:[0,1,1] neg_lo:[1,0,0]
    v_cvt_pk_bf16_f32 v185, v68, -v69
    v_cvt_pk_bf16_f32 v197, v74, -v75
    v_pk_mul_f32 v[42:43], v[68:69], v[26:27] op_sel:[0,0] op_sel_hi:[1,0]
    v_pk_mul_f32 v[52:53], v[74:75], v[30:31] op_sel:[0,0] op_sel_hi:[1,0]
    v_pk_fma_f32 v[70:71], v[68:69], v[26:27], v[42:43] op_sel:[1,1,0] op_sel_hi:[0,1,1] neg_lo:[1,0,0]
    v_pk_fma_f32 v[74:75], v[74:75], v[30:31], v[52:53] op_sel:[1,1,0] op_sel_hi:[0,1,1] neg_lo:[1,0,0]
    v_cvt_pk_bf16_f32 v186, v70, -v71
    v_cvt_pk_bf16_f32 v198, v74, -v75
    v_pk_mul_f32 v[42:43], v[70:71], v[26:27] op_sel:[0,0] op_sel_hi:[1,0]
    v_pk_mul_f32 v[52:53], v[74:75], v[30:31] op_sel:[0,0] op_sel_hi:[1,0]
    v_pk_fma_f32 v[72:73], v[70:71], v[26:27], v[42:43] op_sel:[1,1,0] op_sel_hi:[0,1,1] neg_lo:[1,0,0]
    v_pk_fma_f32 v[74:75], v[74:75], v[30:31], v[52:53] op_sel:[1,1,0] op_sel_hi:[0,1,1] neg_lo:[1,0,0]
    v_cvt_pk_bf16_f32 v187, v72, -v73
    v_cvt_pk_bf16_f32 v199, v74, -v75
    v_pk_mul_f32 v[42:43], v[66:67], v[30:31] op_sel:[0,0] op_sel_hi:[1,0]
    v_pk_mul_f32 v[52:53], v[74:75], v[30:31] op_sel:[0,0] op_sel_hi:[1,0]
    v_pk_fma_f32 v[76:77], v[66:67], v[30:31], v[42:43] op_sel:[1,1,0] op_sel_hi:[0,1,1] neg_lo:[1,0,0]
    v_pk_fma_f32 v[74:75], v[74:75], v[30:31], v[52:53] op_sel:[1,1,0] op_sel_hi:[0,1,1] neg_lo:[1,0,0]
    v_cvt_pk_bf16_f32 v190, v76, -v77
    v_cvt_pk_bf16_f32 v200, v74, -v75
    v_pk_mul_f32 v[42:43], v[76:77], v[30:31] op_sel:[0,0] op_sel_hi:[1,0]
    v_pk_mul_f32 v[52:53], v[62:63], v[30:31] op_sel:[0,0] op_sel_hi:[1,0]
    v_pk_fma_f32 v[76:77], v[76:77], v[30:31], v[42:43] op_sel:[1,1,0] op_sel_hi:[0,1,1] neg_lo:[1,0,0]
    v_pk_fma_f32 v[74:75], v[62:63], v[30:31], v[52:53] op_sel:[1,1,0] op_sel_hi:[0,1,1] neg_lo:[1,0,0]
    v_cvt_pk_bf16_f32 v193, v76, -v77
    v_cvt_pk_bf16_f32 v189, v74, -v75
    v_pk_mul_f32 v[42:43], v[76:77], v[30:31] op_sel:[0,0] op_sel_hi:[1,0]
    v_pk_mul_f32 v[52:53], v[70:71], v[30:31] op_sel:[0,0] op_sel_hi:[1,0]
    v_pk_fma_f32 v[76:77], v[76:77], v[30:31], v[42:43] op_sel:[1,1,0] op_sel_hi:[0,1,1] neg_lo:[1,0,0]
    v_pk_fma_f32 v[74:75], v[70:71], v[30:31], v[52:53] op_sel:[1,1,0] op_sel_hi:[0,1,1] neg_lo:[1,0,0]
    v_cvt_pk_bf16_f32 v195, v76, -v77
    v_cvt_pk_bf16_f32 v191, v74, -v75
    v_and_b32 v36, 0xffff0000, v8
    v_and_b32 v37, 0xffff0000, v9
    v_mul_f32 v36, 0x3fb8aa3b, v36
    v_and_b32 v34, 0xffff0000, v10
    v_exp_f32 v36, v36
    v_and_b32 v35, 0xffff0000, v11
    v_mul_f32 v37, v37, v12
    v_cvt_pk_bf16_f32 v36, v36, v36
    v_mul_f32 v37, 0x3e22f983, v37
    v_and_b32 v36, 0xffff0000, v36
    v_mul_f32 v34, v34, v13
    v_mul_f32 v36, v36, v12
    v_mul_f32 v35, v35, v13
    v_mul_f32 v36, 0xbfb8aa3b, v36
    v_mul_f32 v38, 0x41000000, v37
    v_mul_f32 v39, 0x43800000, v37
    v_mul_f32 v40, 0x41000000, v36
    v_mul_f32 v41, 0x43800000, v36
    v_fract_f32 v38, v38
    v_fract_f32 v39, v39
    v_fract_f32 v37, v37
    v_exp_f32 v40, v40
    v_cos_f32 v28, v38
    v_sin_f32 v29, v38
    v_exp_f32 v36, v36
    v_mul_f32 v28, v28, v40
    v_mul_f32 v29, v29, v40
    v_cos_f32 v26, v37
    v_sin_f32 v27, v37
    v_exp_f32 v41, v41
    v_mul_f32 v26, v26, v36
    v_mul_f32 v27, v27, v36
    v_cos_f32 v30, v39
    v_sin_f32 v31, v39
    v_mul_f32 v32, v29, v29
    v_mul_f32 v33, v28, v29
    v_mul_f32 v30, v30, v41
    v_mul_f32 v31, v31, v41
    v_fma_f32 v32, v28, v28, -v32
    v_add_f32 v33, v33, v33
    s_setprio 3
    s_barrier
    ds_read_b64_tr_b16 v[80:81], v78 offset:0
    ds_read_b64_tr_b16 v[82:83], v78 offset:2048
    ds_read_b64_tr_b16 v[84:85], v78 offset:4096
    ds_read_b64_tr_b16 v[86:87], v78 offset:6144
    ds_read_b64_tr_b16 v[88:89], v78 offset:8192
    ds_read_b64_tr_b16 v[90:91], v78 offset:10240
    s_waitcnt lgkmcnt(4)
    buffer_store_dwordx4 v[80:83], v79, s[92:95], 0 offen sc1
    s_waitcnt lgkmcnt(2)
    buffer_store_dwordx4 v[84:87], v79, s[92:95], s54 offen sc1
    s_waitcnt lgkmcnt(0)
    buffer_store_dwordx4 v[88:91], v79, s[92:95], s55 offen sc1
    s_setprio 0
    s_waitcnt vmcnt(3)
    v_mov_b32 v201, 0x3f80
    v_cvt_pk_bf16_f32 v202, v28, v29
    v_mul_f32 v42, v29, v33
    v_mul_f32 v43, v29, v32
    v_fma_f32 v47, v28, v33, v43
    v_fma_f32 v46, v28, v32, -v42
    v_cvt_pk_bf16_f32 v203, v32, v33
    v_cvt_pk_bf16_f32 v204, v46, v47
    v_mul_f32 v42, v47, v33
    v_mul_f32 v43, v47, v32
    v_mul_f32 v52, v33, v33
    v_mul_f32 v53, v33, v32
    v_fma_f32 v47, v46, v33, v43
    v_fma_f32 v46, v46, v32, -v42
    v_fma_f32 v45, v32, v33, v53
    v_fma_f32 v44, v32, v32, -v52
    v_cvt_pk_bf16_f32 v205, v44, v45
    v_cvt_pk_bf16_f32 v206, v46, v47
    v_mul_f32 v42, v47, v33
    v_mul_f32 v43, v47, v32
    v_mul_f32 v52, v45, v33
    v_mul_f32 v53, v45, v32
    v_fma_f32 v47, v46, v33, v43
    v_fma_f32 v46, v46, v32, -v42
    v_fma_f32 v45, v44, v33, v53
    v_fma_f32 v44, v44, v32, -v52
    v_cvt_pk_bf16_f32 v207, v44, v45
    v_cvt_pk_bf16_f32 v208, v46, v47
    v_mul_f32 v42, v47, v33
    v_mul_f32 v43, v47, v32
    s_setprio 3
    global_load_dword v6, v7, s[98:99] sc1
    s_setprio 0
    v_mul_f32 v52, v45, v33
    v_mul_f32 v53, v45, v32
    v_fma_f32 v47, v46, v33, v43
    v_fma_f32 v46, v46, v32, -v42
    v_fma_f32 v45, v44, v33, v53
    v_fma_f32 v44, v44, v32, -v52
    v_cvt_pk_bf16_f32 v209, v44, v45
    v_cvt_pk_bf16_f32 v210, v46, v47
    v_mul_f32 v42, v47, v33
    v_mul_f32 v43, v47, v32
    v_mul_f32 v52, v45, v33
    v_mul_f32 v53, v45, v32
    v_fma_f32 v47, v46, v33, v43
    v_fma_f32 v46, v46, v32, -v42
    v_fma_f32 v45, v44, v33, v53
    v_fma_f32 v44, v44, v32, -v52
    v_cvt_pk_bf16_f32 v211, v44, v45
    v_cvt_pk_bf16_f32 v212, v46, v47
    v_mul_f32 v42, v47, v33
    v_mul_f32 v43, v47, v32
    v_mul_f32 v52, v45, v33
    v_mul_f32 v53, v45, v32
    v_fma_f32 v47, v46, v33, v43
    v_fma_f32 v46, v46, v32, -v42
    v_fma_f32 v45, v44, v33, v53
    v_fma_f32 v44, v44, v32, -v52
    v_cvt_pk_bf16_f32 v213, v44, v45
    v_cvt_pk_bf16_f32 v214, v46, v47
    v_mul_f32 v42, v47, v33
    v_mul_f32 v43, v47, v32
    v_mul_f32 v52, v45, v33
    v_mul_f32 v53, v45, v32
    v_fma_f32 v47, v46, v33, v43
    v_fma_f32 v46, v46, v32, -v42
    v_fma_f32 v45, v44, v33, v53
    v_fma_f32 v44, v44, v32, -v52
    v_cvt_pk_bf16_f32 v215, v44, v45
    v_cvt_pk_bf16_f32 v216, v46, v47
    v_mul_f32 v42, v47, v33
    v_mul_f32 v43, v47, v32
    v_mul_f32 v52, v45, v33
    v_mul_f32 v53, v45, v32
    v_fma_f32 v47, v46, v33, v43
    v_fma_f32 v46, v46, v32, -v42
    v_fma_f32 v45, v44, v33, v53
    v_fma_f32 v44, v44, v32, -v52
    v_cvt_pk_bf16_f32 v217, v44, v45
    v_cvt_pk_bf16_f32 v218, v46, v47
    v_mul_f32 v42, v47, v33
    v_mul_f32 v43, v47, v32
    v_mul_f32 v52, v45, v33
    v_mul_f32 v53, v45, v32
    v_fma_f32 v47, v46, v33, v43
    v_fma_f32 v46, v46, v32, -v42
    v_fma_f32 v45, v44, v33, v53
    v_fma_f32 v44, v44, v32, -v52
    v_cvt_pk_bf16_f32 v219, v44, v45
    v_cvt_pk_bf16_f32 v220, v46, v47
    v_mul_f32 v42, v47, v33
    v_mul_f32 v43, v47, v32
    v_mul_f32 v52, v45, v33
    v_mul_f32 v53, v45, v32
    v_fma_f32 v47, v46, v33, v43
    v_fma_f32 v46, v46, v32, -v42
    v_fma_f32 v45, v44, v33, v53
    v_fma_f32 v44, v44, v32, -v52
    v_cvt_pk_bf16_f32 v221, v44, v45
    v_cvt_pk_bf16_f32 v222, v46, v47
    v_mul_f32 v42, v47, v33
    v_mul_f32 v43, v47, v32
    v_mul_f32 v52, v45, v33
    v_mul_f32 v53, v45, v32
    v_fma_f32 v47, v46, v33, v43
    v_fma_f32 v46, v46, v32, -v42
    v_fma_f32 v45, v44, v33, v53
    v_fma_f32 v44, v44, v32, -v52
    v_cvt_pk_bf16_f32 v223, v44, v45
    v_cvt_pk_bf16_f32 v224, v46, v47
    v_mul_f32 v42, v47, v33
    v_mul_f32 v43, v47, v32
    s_barrier
    s_setprio 3
    s_waitcnt vmcnt(0)
    v_cmp_eq_u32 vcc, 0, v6
    s_cbranch_vccnz L_hs
L_hs_ok:
    s_mov_b64 exec, 1
    global_atomic_add v92, v93, s[60:61] sc1
    s_mov_b64 exec, -1
    s_setprio 0
    v_mul_f32 v52, v45, v33
    v_mul_f32 v53, v45, v32
    v_fma_f32 v47, v46, v33, v43
    v_fma_f32 v46, v46, v32, -v42
    v_fma_f32 v45, v44, v33, v53
    v_fma_f32 v44, v44, v32, -v52
    v_cvt_pk_bf16_f32 v225, v44, v45
    v_cvt_pk_bf16_f32 v226, v46, v47
    v_mul_f32 v42, v47, v33
    v_mul_f32 v43, v47, v32
    v_mul_f32 v52, v45, v33
    v_mul_f32 v53, v45, v32
    v_fma_f32 v47, v46, v33, v43
    v_fma_f32 v46, v46, v32, -v42
    v_fma_f32 v45, v44, v33, v53
    v_fma_f32 v44, v44, v32, -v52
    v_cvt_pk_bf16_f32 v227, v44, v45
    v_cvt_pk_bf16_f32 v228, v46, v47
    v_mul_f32 v42, v47, v33
    v_mul_f32 v43, v47, v32
    v_mul_f32 v52, v45, v33
    v_mul_f32 v53, v45, v32
    v_fma_f32 v47, v46, v33, v43
    v_fma_f32 v46, v46, v32, -v42
    v_fma_f32 v45, v44, v33, v53
    v_fma_f32 v44, v44, v32, -v52
    v_cvt_pk_bf16_f32 v229, v44, v45
    v_cvt_pk_bf16_f32 v230, v46, v47
    v_mul_f32 v42, v47, v33
    v_mul_f32 v43, v47, v32
    v_mul_f32 v52, v45, v33
    v_mul_f32 v53, v45, v32
    v_fma_f32 v47, v46, v33, v43
    v_fma_f32 v46, v46, v32, -v42
    v_fma_f32 v45, v44, v33, v53
    v_fma_f32 v44, v44, v32, -v52
    v_cvt_pk_bf16_f32 v231, v44, v45
    v_cvt_pk_bf16_f32 v232, v46, v47
    v_cvt_pk_bf16_f32 v233, v34, -v35
    v_mul_f32 v42, v35, v27
    v_mul_f32 v43, v35, v26
    v_mul_f32 v52, v35, v31
    v_mul_f32 v53, v35, v30
    v_fma_f32 v61, v34, v27, v43
    v_fma_f32 v60, v34, v26, -v42
    v_fma_f32 v75, v34, v31, v53
    v_fma_f32 v74, v34, v30, -v52
    v_cvt_pk_bf16_f32 v234, v60, -v61
    v_cvt_pk_bf16_f32 v241, v74, -v75
    v_mul_f32 v42, v61, v27
    v_mul_f32 v43, v61, v26
    v_mul_f32 v52, v75, v31
    v_mul_f32 v53, v75, v30
    v_fma_f32 v63, v60, v27, v43
    v_fma_f32 v62, v60, v26, -v42
    v_fma_f32 v75, v74, v31, v53
    v_fma_f32 v74, v74, v30, -v52
    v_cvt_pk_bf16_f32 v235, v62, -v63
    v_cvt_pk_bf16_f32 v245, v74, -v75
    v_mul_f32 v42, v63, v27
    v_mul_f32 v43, v63, v26
    v_mul_f32 v52, v75, v31
    v_mul_f32 v53, v75, v30
    v_fma_f32 v65, v62, v27, v43
    v_fma_f32 v64, v62, v26, -v42
    v_fma_f32 v75, v74, v31, v53
    v_fma_f32 v74, v74, v30, -v52
    v_cvt_pk_bf16_f32 v236, v64, -v65
    v_cvt_pk_bf16_f32 v247, v74, -v75
    v_mul_f32 v42, v65, v27
    v_mul_f32 v43, v65, v26
    v_mul_f32 v52, v75, v31
    v_mul_f32 v53, v75, v30
    v_fma_f32 v67, v64, v27, v43
    v_fma_f32 v66, v64, v26, -v42
    v_fma_f32 v75, v74, v31, v53
    v_fma_f32 v74, v74, v30, -v52
    v_cvt_pk_bf16_f32 v237, v66, -v67
    v_cvt_pk_bf16_f32 v249, v74, -v75
    v_mul_f32 v42, v67, v27
    v_mul_f32 v43, v67, v26
    v_mul_f32 v52, v75, v31
    v_mul_f32 v53, v75, v30
    v_fma_f32 v69, v66, v27, v43
    v_fma_f32 v68, v66, v26, -v42
    v_fma_f32 v75, v74, v31, v53
    v_fma_f32 v74, v74, v30, -v52
    v_cvt_pk_bf16_f32 v238, v68, -v69
    v_cvt_pk_bf16_f32 v250, v74, -v75
    v_mul_f32 v42, v69, v27
    v_mul_f32 v43, v69, v26
    v_mul_f32 v52, v75, v31
    v_mul_f32 v53, v75, v30
    v_fma_f32 v71, v68, v27, v43
    v_fma_f32 v70, v68, v26, -v42
    v_fma_f32 v75, v74, v31, v53
    v_fma_f32 v74, v74, v30, -v52
    v_cvt_pk_bf16_f32 v239, v70, -v71
    v_cvt_pk_bf16_f32 v251, v74, -v75
    v_mul_f32 v42, v71, v27
    v_mul_f32 v43, v71, v26
    v_mul_f32 v52, v75, v31
    v_mul_f32 v53, v75, v30
    v_fma_f32 v73, v70, v27, v43
    v_fma_f32 v72, v70, v26, -v42
    v_fma_f32 v75, v74, v31, v53
    v_fma_f32 v74, v74, v30, -v52
    v_cvt_pk_bf16_f32 v240, v72, -v73
    v_cvt_pk_bf16_f32 v252, v74, -v75
    v_mul_f32 v42, v67, v31
    v_mul_f32 v43, v67, v30
    v_mul_f32 v52, v75, v31
    v_mul_f32 v53, v75, v30
    v_fma_f32 v77, v66, v31, v43
    v_fma_f32 v76, v66, v30, -v42
    v_fma_f32 v75, v74, v31, v53
    v_fma_f32 v74, v74, v30, -v52
    v_cvt_pk_bf16_f32 v243, v76, -v77
    v_cvt_pk_bf16_f32 v253, v74, -v75
    v_mul_f32 v42, v77, v31
    v_mul_f32 v43, v77, v30
    v_mul_f32 v52, v63, v31
    v_mul_f32 v53, v63, v30
    v_fma_f32 v77, v76, v31, v43
    v_fma_f32 v76, v76, v30, -v42
    v_fma_f32 v75, v62, v31, v53
    v_fma_f32 v74, v62, v30, -v52
    v_cvt_pk_bf16_f32 v246, v76, -v77
    v_cvt_pk_bf16_f32 v242, v74, -v75
    v_mul_f32 v42, v77, v31
    v_mul_f32 v43, v77, v30
    v_mul_f32 v52, v71, v31
    v_mul_f32 v53, v71, v30
    v_fma_f32 v77, v76, v31, v43
    v_fma_f32 v76, v76, v30, -v42
    v_fma_f32 v75, v70, v31, v53
    v_fma_f32 v74, v70, v30, -v52
    v_cvt_pk_bf16_f32 v248, v76, -v77
    v_cvt_pk_bf16_f32 v244, v74, -v75
    s_barrier
    s_cmp_ge_u32 s2, 224
    s_cselect_b32 s11, 1, 0
    s_add_u32 s59, s57, 1
    s_sub_u32 s58, s59, 7
    s_min_u32 s59, s59, s58
    s_lshl_b32 s59, s59, 7
    s_add_u32 m0, s45, 132480
    s_add_u32 s41, s59, 57344
    buffer_load_dwordx4 v2, s[28:31], s41 offen lds
    s_add_u32 s59, s57, 2
    s_sub_u32 s58, s59, 7
    s_min_u32 s59, s59, s58
    s_lshl_b32 s59, s59, 7
    s_add_u32 m0, s45, 136576
    s_add_u32 s41, s59, 57344
    buffer_load_dwordx4 v2, s[28:31], s41 offen lds
    s_add_u32 s59, s57, 3
    s_sub_u32 s58, s59, 7
    s_min_u32 s59, s59, s58
    s_lshl_b32 s59, s59, 7
    s_add_u32 m0, s45, 140672
    s_add_u32 s41, s59, 57344
    buffer_load_dwordx4 v2, s[28:31], s41 offen lds
    s_add_u32 s59, s57, 4
    s_sub_u32 s58, s59, 7
    s_min_u32 s59, s59, s58
    s_lshl_b32 s59, s59, 7
    s_add_u32 m0, s45, 144768
    s_add_u32 s41, s59, 57344
    buffer_load_dwordx4 v2, s[28:31], s41 offen lds
    s_add_u32 s59, s57, 5
    s_sub_u32 s58, s59, 7
    s_min_u32 s59, s59, s58
    s_lshl_b32 s59, s59, 7
    s_add_u32 m0, s45, 148864
    s_add_u32 s41, s59, 57344
    buffer_load_dwordx4 v2, s[28:31], s41 offen lds
    s_add_u32 s59, s57, 6
    s_sub_u32 s58, s59, 7
    s_min_u32 s59, s59, s58
    s_lshl_b32 s59, s59, 7
    s_add_u32 m0, s45, 152960
    s_add_u32 s41, s59, 57344
    buffer_load_dwordx4 v2, s[28:31], s41 offen lds
    s_mov_b64 exec, 1
    global_atomic_add v14, v20, v7, s[60:61] sc0 sc1
    s_mov_b64 exec, -1
    s_barrier
    s_and_b32 s8, s2, 7
    s_lshl_b32 s8, s8, 3
    s_lshr_b32 s40, s2, 5
    s_add_u32 s8, s8, s40
    s_bfe_u32 s9, s2, 0x20003
    s_lshl_b32 s10, s9, 2
    s_add_u32 s10, s10, s50
    v_lshrrev_b32 v36, 4, v0
    v_lshlrev_b32 v37, 2, v36
    v_xor_b32 v37, v37, v0
    v_and_b32 v37, 15, v37
    s_lshl_b32 s40, s50, 2
    v_add_u32 v36, s40, v36
    v_mul_u32_u24 v3, 896, v36
    v_lshl_add_u32 v3, v37, 4, v3
    s_cmp_eq_u32 s9, 3
    s_cselect_b32 s40, 8, 16
    v_cmp_le_u32 vcc, s40, v37
    s_lshl_b32 s40, s9, 8
    s_add_u32 s28, s100, s40
    s_addc_u32 s29, s101, 0
    s_sub_u32 s30, 401408, s40
    v_mov_b32 v37, 0x1000000
    v_cndmask_b32 v3, v3, v37, vcc
    v_bfe_u32 v37, v0, 2, 2
    v_lshl_add_u32 v8, v5, 3, v37
    v_lshlrev_b32 v8, 8, v8
    v_xor_b32 v37, s50, v37
    v_lshl_add_u32 v8, v37, 6, v8
    v_bfe_u32 v37, v0, 4, 1
    v_lshl_add_u32 v8, v37, 5, v8
    v_and_b32 v37, 1, v0
    v_lshl_add_u32 v8, v37, 4, v8
    v_bfe_u32 v37, v0, 1, 1
    v_lshl_add_u32 v8, v37, 3, v8
    v_lshl_add_u32 v9, v5, 11, v8
    v_mul_u32_u24 v37, 12288, v5
    v_add_u32 v10, v37, v8
    s_cmp_lt_u32 s2, 224
    s_cselect_b32 s40, 1, 0
    v_mov_b32 v1, s40
    s_lshr_b32 s40, s8, 4
    s_mul_i32 s41, s40, 14
    s_add_u32 s41, s41, s10
    s_lshl_b32 s41, s41, 8
    s_add_u32 s41, s41, 8
    v_mov_b32 v11, s41
    v_lshlrev_b32 v12, 2, v4
    v_lshl_add_u32 v13, v5, 15, v12
    s_barrier
    s_setprio 1
    s_waitcnt vmcnt(1)
    s_cmp_eq_u32 s11, 0
    s_cbranch_scc1 L_uc_1
L_ub_1:
    s_mov_b32 m0, s18
    s_nop 0
    s_barrier
    s_cmp_ge_u32 s2, 224
    s_cbranch_scc1 L_p3
    ds_write_addtid_b32 v148 offset:0
    ds_write_addtid_b32 v149 offset:272
    ds_write_addtid_b32 v150 offset:544
    ds_write_addtid_b32 v151 offset:816
    ds_write_addtid_b32 v152 offset:1088
    ds_write_addtid_b32 v153 offset:1360
    v_mov_b32 v28, 0
    ds_write_addtid_b32 v154 offset:1632
    ds_write_addtid_b32 v155 offset:1904
    ds_write_addtid_b32 v156 offset:2176
    ds_write_addtid_b32 v157 offset:2448
    ds_write_addtid_b32 v158 offset:2720
    ds_write_addtid_b32 v159 offset:2992
    v_mov_b32 v29, 0
    ds_write_addtid_b32 v160 offset:3264
    ds_write_addtid_b32 v161 offset:3536
    ds_write_addtid_b32 v162 offset:3808
    ds_write_addtid_b32 v163 offset:4080
    ds_write_addtid_b32 v164 offset:4352
    ds_write_addtid_b32 v165 offset:4624
    v_mov_b32 v30, 0
    ds_write_addtid_b32 v166 offset:4896
    ds_write_addtid_b32 v167 offset:5168
    ds_write_addtid_b32 v168 offset:5440
    ds_write_addtid_b32 v169 offset:5712
    ds_write_addtid_b32 v170 offset:5984
    ds_write_addtid_b32 v171 offset:6256
    v_mov_b32 v31, 0
    ds_write_addtid_b32 v172 offset:6528
    ds_write_addtid_b32 v173 offset:6800
    ds_write_addtid_b32 v174 offset:7072
    ds_write_addtid_b32 v175 offset:7344
    ds_write_addtid_b32 v176 offset:7616
    ds_write_addtid_b32 v177 offset:7888
    v_lshl_add_u32 v6, v0, 3, s13
    ds_write_addtid_b32 v178 offset:8160
    ds_write_addtid_b32 v179 offset:8432
    ds_read_b128 v[80:83], v24 offset:0
    ds_read_b128 v[84:87], v24 offset:32
    ds_read_b128 v[88:91], v24 offset:64
    ds_read_b128 v[92:95], v24 offset:96
    ds_write_b64 v6, v[28:29]
    ds_read_b128 v[96:99], v24 offset:128
    ds_read_b128 v[100:103], v24 offset:160
    ds_read_b128 v[104:107], v24 offset:192
    ds_read_b128 v[108:111], v24 offset:224
    ds_write_addtid_b32 v180 offset:0
    ds_write_addtid_b32 v181 offset:272
    v_add_u32 v6, s19, v0
    ds_write_addtid_b32 v182 offset:544
    ds_write_addtid_b32 v183 offset:816
    ds_write_addtid_b32 v184 offset:1088
    ds_write_addtid_b32 v185 offset:1360
    ds_write_addtid_b32 v186 offset:1632
    ds_write_addtid_b32 v187 offset:1904
    ds_write_b8 v6, v28
    ds_write_addtid_b32 v188 offset:2176
    ds_write_addtid_b32 v189 offset:2448
    ds_write_addtid_b32 v190 offset:2720
    ds_write_addtid_b32 v200 offset:2992
    ds_write_addtid_b32 v190 offset:3264
    ds_write_addtid_b32 v191 offset:3536
    s_xor_b32 s41, s50, 1
    ds_write_addtid_b32 v188 offset:3808
    ds_write_addtid_b32 v192 offset:4352
    ds_write_addtid_b32 v193 offset:4624
    ds_write_addtid_b32 v196 offset:4896
    ds_write_addtid_b32 v198 offset:5168
    ds_write_addtid_b32 v194 offset:5440
    s_mul_i32 s41, s41, 3072
    s_cmp_eq_u32 s11, 0
    s_cbranch_scc1 L_uc_2
L_ub_2:
    s_nop 0
    ds_write_addtid_b32 v195 offset:5712
    ds_write_addtid_b32 v197 offset:5984
    ds_write_addtid_b32 v199 offset:6256
    ds_read_b128 v[112:115], v24 offset:0
    ds_read_b128 v[116:119], v24 offset:32
    ds_read_b128 v[120:123], v24 offset:64
    s_add_u32 s41, s41, 34816
    ds_read_b128 v[124:127], v24 offset:96
    ds_read_b128 v[128:131], v24 offset:128
    ds_read_b128 v[132:135], v24 offset:160
    ds_read_b128 v[136:139], v24 offset:192
    ds_read_b128 v[140:143], v24 offset:224
    v_lshl_add_u32 v27, v0, 4, s41
    ds_write_addtid_b32 v201 offset:0
    ds_write_addtid_b32 v202 offset:272
    ds_write_addtid_b32 v203 offset:544
    ds_write_addtid_b32 v204 offset:816
    ds_write_addtid_b32 v205 offset:1088
    ds_write_addtid_b32 v206 offset:1360
    ds_write_addtid_b32 v207 offset:1632
    ds_write_addtid_b32 v208 offset:1904
    ds_write_addtid_b32 v209 offset:2176
    ds_write_addtid_b32 v210 offset:2448
    ds_write_addtid_b32 v211 offset:2720
    ds_write_addtid_b32 v212 offset:2992
    ds_write_addtid_b32 v213 offset:3264
    ds_write_addtid_b32 v214 offset:3536
    ds_write_addtid_b32 v215 offset:3808
    ds_write_addtid_b32 v216 offset:4080
    ds_write_addtid_b32 v217 offset:4352
    ds_write_addtid_b32 v218 offset:4624
    ds_write_addtid_b32 v219 offset:4896
    ds_write_addtid_b32 v220 offset:5168
    ds_write_addtid_b32 v221 offset:5440
    ds_write_addtid_b32 v222 offset:5712
    ds_write_addtid_b32 v223 offset:5984
    ds_write_addtid_b32 v224 offset:6256
    ds_write_addtid_b32 v225 offset:6528
    ds_write_addtid_b32 v226 offset:6800
    ds_write_addtid_b32 v227 offset:7072
    ds_write_addtid_b32 v228 offset:7344
    ds_write_addtid_b32 v229 offset:7616
    ds_write_addtid_b32 v230 offset:7888
    ds_write_addtid_b32 v231 offset:8160
    ds_write_addtid_b32 v232 offset:8432
    ds_read_b128 v[148:151], v24 offset:0
    ds_read_b128 v[152:155], v24 offset:32
    ds_read_b128 v[156:159], v24 offset:64
    ds_read_b128 v[160:163], v24 offset:96
    ds_read_b128 v[164:167], v24 offset:128
    ds_read_b128 v[168:171], v24 offset:160
    ds_read_b128 v[172:175], v24 offset:192
    ds_read_b128 v[176:179], v24 offset:224
    s_waitcnt lgkmcnt(15)
    v_mfma_f32_32x32x16_bf16 v[180:195], v[112:115], v[80:83], 0
    ds_write_addtid_b32 v233 offset:0
    ds_write_addtid_b32 v234 offset:272
    ds_write_addtid_b32 v235 offset:544
    ds_write_addtid_b32 v236 offset:816
    v_mfma_f32_32x32x16_bf16 v[180:195], v[116:119], v[84:87], v[180:195]
    ds_write_addtid_b32 v237 offset:1088
    ds_write_addtid_b32 v238 offset:1360
    ds_write_addtid_b32 v239 offset:1632
    ds_write_addtid_b32 v240 offset:1904
    v_mfma_f32_32x32x16_bf16 v[180:195], v[120:123], v[88:91], v[180:195]
    ds_write_addtid_b32 v241 offset:2176
    ds_write_addtid_b32 v242 offset:2448
    ds_write_addtid_b32 v243 offset:2720
    ds_write_addtid_b32 v253 offset:2992
    v_mfma_f32_32x32x16_bf16 v[180:195], v[124:127], v[92:95], v[180:195]
    ds_write_addtid_b32 v243 offset:3264
    ds_write_addtid_b32 v244 offset:3536
    ds_write_addtid_b32 v241 offset:3808
    ds_write_addtid_b32 v245 offset:4352
    v_mfma_f32_32x32x16_bf16 v[180:195], v[128:131], v[96:99], v[180:195]
    ds_write_addtid_b32 v246 offset:4624
    ds_write_addtid_b32 v249 offset:4896
    ds_write_addtid_b32 v251 offset:5168
    ds_write_addtid_b32 v247 offset:5440
    v_mfma_f32_32x32x16_bf16 v[180:195], v[132:135], v[100:103], v[180:195]
    ds_write_addtid_b32 v248 offset:5712
    ds_write_addtid_b32 v250 offset:5984
    ds_write_addtid_b32 v252 offset:6256
    ds_read_b128 v[36:39], v24 offset:0
    v_mfma_f32_32x32x16_bf16 v[180:195], v[136:139], v[104:107], v[180:195]
    ds_read_b128 v[40:43], v24 offset:32
    ds_read_b128 v[44:47], v24 offset:64
    ds_read_b128 v[48:51], v24 offset:96
    ds_read_b128 v[52:55], v24 offset:128
    v_mfma_f32_32x32x16_bf16 v[180:195], v[140:143], v[108:111], v[180:195]
    ds_read_b128 v[56:59], v24 offset:160
    ds_read_b128 v[60:63], v24 offset:192
    ds_read_b128 v[64:67], v24 offset:224
    s_waitcnt lgkmcnt(7)
    v_mfma_f32_32x32x16_bf16 v[180:195], v[36:39], v[148:151], v[180:195]
    s_waitcnt lgkmcnt(6)
    v_mfma_f32_32x32x16_bf16 v[180:195], v[40:43], v[152:155], v[180:195]
    s_waitcnt lgkmcnt(5)
    v_mfma_f32_32x32x16_bf16 v[180:195], v[44:47], v[156:159], v[180:195]
    s_waitcnt lgkmcnt(4)
    v_mfma_f32_32x32x16_bf16 v[180:195], v[48:51], v[160:163], v[180:195]
    s_waitcnt lgkmcnt(3)
    v_mfma_f32_32x32x16_bf16 v[180:195], v[52:55], v[164:167], v[180:195]
    s_waitcnt lgkmcnt(2)
    v_mfma_f32_32x32x16_bf16 v[180:195], v[56:59], v[168:171], v[180:195]
    s_waitcnt lgkmcnt(1)
    v_mfma_f32_32x32x16_bf16 v[180:195], v[60:63], v[172:175], v[180:195]
    s_waitcnt lgkmcnt(0)
    v_mfma_f32_32x32x16_bf16 v[180:195], v[64:67], v[176:179], v[180:195]
    s_cmp_eq_u32 s11, 0
    s_cbranch_scc1 L_u_late
L_u_done:
    v_mov_b32 v15, 1
    v_xor_b32 v6, 4, v255
    v_mov_b32 v36, 0
    v_and_b32 v37, 1, v0
    v_writelane_b32 v36, s44, 0
    v_cmp_eq_u32 vcc, 1, v37
    s_nop 3
    ds_write_b128 v25, v[180:183]
    ds_write_b128 v25, v[184:187] offset:1024
    ds_write_b128 v25, v[188:191] offset:2048
    s_waitcnt vmcnt(0)
    ds_write_b32 v255, v15
L_xch:
    ds_read_b32 v14, v6
    ds_read_b128 v[60:63], v27
    ds_read_b128 v[64:67], v27 offset:1024
    ds_read_b128 v[68:71], v27 offset:2048
    s_waitcnt lgkmcnt(3)
    v_readfirstlane_b32 s40, v14
    s_cmp_eq_u32 s40, 0
    s_cbranch_scc1 L_xch
    s_mov_b64 exec, 1
    ds_add_u32 v23, v15 offset:4
    s_mov_b64 exec, -1
    s_waitcnt lgkmcnt(3)
    v_pk_add_f32 v[180:181], v[180:181], v[60:61]
    v_pk_add_f32 v[182:183], v[182:183], v[62:63]
    s_waitcnt lgkmcnt(2)
    v_pk_add_f32 v[184:185], v[184:185], v[64:65]
    v_pk_add_f32 v[186:187], v[186:187], v[66:67]
    s_waitcnt lgkmcnt(1)
    v_pk_add_f32 v[188:189], v[188:189], v[68:69]
    v_pk_add_f32 v[190:191], v[190:191], v[70:71]
    v_add_f32 v180, v180, v36
    v_cvt_pk_bf16_f32 v45, v182, v183
    v_cvt_pk_bf16_f32 v44, v180, v181
    v_mov_b32_dpp v40, v188 wave_rol:1 row_mask:0xf bank_mask:0xf
    ds_write_b64 v254, v[44:45] offset:0
    v_mov_b32_dpp v41, v190 wave_rol:1 row_mask:0xf bank_mask:0xf
    v_mov_b32_dpp v40, v186 wave_shl:1 row_mask:0xc bank_mask:0xf
    v_cvt_pk_bf16_f32 v46, v184, v184
    v_mov_b32_dpp v41, v188 wave_shl:1 row_mask:0xf bank_mask:0xf
    v_mov_b32_dpp v40, v186 quad_perm:[0,1,2,3] row_mask:0x3 bank_mask:0xf
    v_cvt_pk_bf16_f32 v48, v188, v188
    v_cvt_pk_bf16_f32 v47, v185, v40
    v_cvt_pk_bf16_f32 v49, v188, v189
    ds_write_b64 v254, v[46:47] offset:512
    v_cvt_pk_bf16_f32 v50, v189, v189
    v_cvt_pk_bf16_f32 v51, v41, v41
    v_mov_b32_dpp v42, v191 wave_rol:1 row_mask:0xf bank_mask:0xf
    ds_write_b128 v18, v[48:51] offset:1024
    v_mov_b32_dpp v43, v187 wave_rol:1 row_mask:0xf bank_mask:0xf
    v_mov_b32_dpp v42, v190 wave_shl:1 row_mask:0xf bank_mask:0xf
    v_cvt_pk_bf16_f32 v52, v190, v190
    v_mov_b32_dpp v43, v191 wave_shl:1 row_mask:0xf bank_mask:0xf
    v_cndmask_b32 v38, v190, v42, vcc
    v_cvt_pk_bf16_f32 v55, v42, v42
    v_mov_b32 v53, v52
    v_cvt_pk_bf16_f32 v54, v38, v42
    v_cndmask_b32 v39, v191, v43, vcc
    ds_write_b128 v18, v[52:55] offset:2048
    v_cvt_pk_bf16_f32 v56, v191, v191
    v_cvt_pk_bf16_f32 v59, v43, v43
    v_cvt_pk_bf16_f32 v58, v39, v43
    v_mov_b32 v57, v56
    ds_write_b128 v18, v[56:59] offset:3072
    s_mul_i32 m0, s47, 8224
    s_bitcmp1_b32 s50, 0
    s_cbranch_scc1 L_cB
    ds_read_b64_tr_b16 v[32:33], v16 offset:32
    ds_read_b64_tr_b16 v[34:35], v16 offset:0
    ds_read_b128 v[188:191], v17 offset:3968
    ds_read_b128 v[140:143], v17 offset:2432
    ds_read_b128 v[124:127], v17 offset:1920
    ds_read_b128 v[76:79], v17 offset:384
    ds_read_b64_tr_b16 v[36:37], v16 offset:160
    ds_read_b64_tr_b16 v[38:39], v16 offset:128
    ds_read_b128 v[184:187], v17 offset:3840
    ds_read_b128 v[136:139], v17 offset:2304
    ds_read_b128 v[120:123], v17 offset:1792
    ds_read_b128 v[72:75], v17 offset:256
    s_setprio 0
    s_waitcnt lgkmcnt(6)
    v_mfma_f32_32x32x16_bf16 v[192:207], v[188:191], v[32:35], 0
    ds_read_b64_tr_b16 v[40:41], v16 offset:288
    ds_read_b64_tr_b16 v[42:43], v16 offset:256
    v_mfma_f32_32x32x16_bf16 v[208:223], v[140:143], v[32:35], 0
    ds_read_b128 v[180:183], v17 offset:3712
    ds_read_b128 v[132:135], v17 offset:2176
    v_mfma_f32_32x32x16_bf16 v[224:239], v[124:127], v[32:35], 0
    ds_read_b128 v[116:119], v17 offset:1664
    ds_read_b128 v[68:71], v17 offset:128
    v_mfma_f32_32x32x16_bf16 v[240:255], v[76:79], v[32:35], 0
    s_waitcnt lgkmcnt(6)
    v_mfma_f32_32x32x16_bf16 v[192:207], v[184:187], v[36:39], v[192:207]
    ds_read_b64_tr_b16 v[44:45], v16 offset:416
    ds_read_b64_tr_b16 v[46:47], v16 offset:384
    v_mfma_f32_32x32x16_bf16 v[208:223], v[136:139], v[36:39], v[208:223]
    ds_read_b128 v[176:179], v17 offset:3584
    ds_read_b128 v[128:131], v17 offset:2048
    v_mfma_f32_32x32x16_bf16 v[224:239], v[120:123], v[36:39], v[224:239]
    ds_read_b128 v[112:115], v17 offset:1536
    ds_read_b128 v[64:67], v17 offset:0
    v_mfma_f32_32x32x16_bf16 v[240:255], v[72:75], v[36:39], v[240:255]
    s_waitcnt lgkmcnt(6)
    v_mfma_f32_32x32x16_bf16 v[192:207], v[180:183], v[40:43], v[192:207]
    ds_read_b64_tr_b16 v[48:49], v16 offset:544
    ds_read_b64_tr_b16 v[50:51], v16 offset:512
    v_mfma_f32_32x32x16_bf16 v[208:223], v[132:135], v[40:43], v[208:223]
    ds_read_b128 v[172:175], v17 offset:3456
    ds_read_b128 v[108:111], v17 offset:1408
    v_mfma_f32_32x32x16_bf16 v[224:239], v[116:119], v[40:43], v[224:239]
    ds_read_b64_tr_b16 v[52:53], v16 offset:672
    ds_read_b64_tr_b16 v[54:55], v16 offset:640
    v_mfma_f32_32x32x16_bf16 v[240:255], v[68:71], v[40:43], v[240:255]
    s_waitcnt lgkmcnt(6)
    v_mfma_f32_32x32x16_bf16 v[192:207], v[176:179], v[44:47], v[192:207]
    ds_read_b128 v[168:171], v17 offset:3328
    ds_read_b128 v[104:107], v17 offset:1280
    v_mfma_f32_32x32x16_bf16 v[208:223], v[128:131], v[44:47], v[208:223]
    ds_read_b64_tr_b16 v[56:57], v16 offset:800
    ds_read_b64_tr_b16 v[58:59], v16 offset:768
    v_mfma_f32_32x32x16_bf16 v[224:239], v[112:115], v[44:47], v[224:239]
    ds_read_b128 v[164:167], v17 offset:3200
    ds_read_b128 v[100:103], v17 offset:1152
    v_mfma_f32_32x32x16_bf16 v[240:255], v[64:67], v[44:47], v[240:255]
    s_waitcnt lgkmcnt(8)
    v_mfma_f32_32x32x16_bf16 v[192:207], v[172:175], v[48:51], v[192:207]
    ds_read_b64_tr_b16 v[60:61], v16 offset:928
    ds_read_b64_tr_b16 v[62:63], v16 offset:896
    v_mfma_f32_32x32x16_bf16 v[208:223], v[124:127], v[48:51], v[208:223]
    ds_read_b128 v[160:163], v17 offset:3072
    ds_read_b128 v[96:99], v17 offset:1024
    v_mfma_f32_32x32x16_bf16 v[224:239], v[108:111], v[48:51], v[224:239]
    s_waitcnt lgkmcnt(8)
    v_mfma_f32_32x32x16_bf16 v[192:207], v[168:171], v[52:55], v[192:207]
    ds_read_b64_tr_b16 v[32:33], v16 offset:1056
    ds_read_b64_tr_b16 v[34:35], v16 offset:1024
    v_mfma_f32_32x32x16_bf16 v[208:223], v[120:123], v[52:55], v[208:223]
    ds_read_b128 v[156:159], v17 offset:2944
    ds_read_b128 v[92:95], v17 offset:896
    v_mfma_f32_32x32x16_bf16 v[224:239], v[104:107], v[52:55], v[224:239]
    s_waitcnt lgkmcnt(8)
    v_mfma_f32_32x32x16_bf16 v[192:207], v[164:167], v[56:59], v[192:207]
    ds_read_b64_tr_b16 v[36:37], v16 offset:1184
    ds_read_b64_tr_b16 v[38:39], v16 offset:1152
    v_mfma_f32_32x32x16_bf16 v[208:223], v[116:119], v[56:59], v[208:223]
    ds_read_b128 v[152:155], v17 offset:2816
    ds_read_b128 v[88:91], v17 offset:768
    v_mfma_f32_32x32x16_bf16 v[224:239], v[100:103], v[56:59], v[224:239]
    s_waitcnt lgkmcnt(8)
    v_mfma_f32_32x32x16_bf16 v[192:207], v[160:163], v[60:63], v[192:207]
    ds_read_b64_tr_b16 v[40:41], v16 offset:1312
    ds_read_b64_tr_b16 v[42:43], v16 offset:1280
    v_mfma_f32_32x32x16_bf16 v[208:223], v[112:115], v[60:63], v[208:223]
    ds_read_b128 v[148:151], v17 offset:2688
    ds_read_b128 v[84:87], v17 offset:640
    v_mfma_f32_32x32x16_bf16 v[224:239], v[96:99], v[60:63], v[224:239]
    s_waitcnt lgkmcnt(8)
    v_mfma_f32_32x32x16_bf16 v[192:207], v[156:159], v[32:35], v[192:207]
    ds_read_b64_tr_b16 v[44:45], v16 offset:1440
    ds_read_b64_tr_b16 v[46:47], v16 offset:1408
    v_mfma_f32_32x32x16_bf16 v[208:223], v[108:111], v[32:35], v[208:223]
    ds_read_b128 v[144:147], v17 offset:2560
    ds_read_b128 v[80:83], v17 offset:512
    v_mfma_f32_32x32x16_bf16 v[224:239], v[92:95], v[32:35], v[224:239]
    s_waitcnt lgkmcnt(8)
    v_mfma_f32_32x32x16_bf16 v[192:207], v[152:155], v[36:39], v[192:207]
    ds_read_b64_tr_b16 v[48:49], v16 offset:1568
    ds_read_b64_tr_b16 v[50:51], v16 offset:1536
    v_mfma_f32_32x32x16_bf16 v[208:223], v[104:107], v[36:39], v[208:223]
    ds_read_b64_tr_b16 v[52:53], v16 offset:1696
    ds_read_b64_tr_b16 v[54:55], v16 offset:1664
    v_mfma_f32_32x32x16_bf16 v[224:239], v[88:91], v[36:39], v[224:239]
    s_waitcnt lgkmcnt(8)
    v_mfma_f32_32x32x16_bf16 v[192:207], v[148:151], v[40:43], v[192:207]
    ds_read_b64_tr_b16 v[56:57], v16 offset:1824
    ds_read_b64_tr_b16 v[58:59], v16 offset:1792
    v_mfma_f32_32x32x16_bf16 v[208:223], v[100:103], v[40:43], v[208:223]
    ds_read_b64_tr_b16 v[60:61], v16 offset:1952
    ds_read_b64_tr_b16 v[62:63], v16 offset:1920
    v_mfma_f32_32x32x16_bf16 v[224:239], v[84:87], v[40:43], v[224:239]
    s_waitcnt lgkmcnt(8)
    v_mfma_f32_32x32x16_bf16 v[192:207], v[144:147], v[44:47], v[192:207]
    ds_read_b64_tr_b16 v[32:33], v16 offset:2080
    ds_read_b64_tr_b16 v[34:35], v16 offset:2048
    v_mfma_f32_32x32x16_bf16 v[208:223], v[96:99], v[44:47], v[208:223]
    ds_read_b64_tr_b16 v[36:37], v16 offset:2208
    ds_read_b64_tr_b16 v[38:39], v16 offset:2176
    v_mfma_f32_32x32x16_bf16 v[224:239], v[80:83], v[44:47], v[224:239]
    s_waitcnt lgkmcnt(10)
    v_mfma_f32_32x32x16_bf16 v[192:207], v[140:143], v[48:51], v[192:207]
    ds_read_b64_tr_b16 v[40:41], v16 offset:2336
    ds_read_b64_tr_b16 v[42:43], v16 offset:2304
    v_mfma_f32_32x32x16_bf16 v[208:223], v[92:95], v[48:51], v[208:223]
    v_mfma_f32_32x32x16_bf16 v[224:239], v[76:79], v[48:51], v[224:239]
    s_waitcnt lgkmcnt(10)
    v_mfma_f32_32x32x16_bf16 v[192:207], v[136:139], v[52:55], v[192:207]
    ds_read_b64_tr_b16 v[44:45], v16 offset:2464
    ds_read_b64_tr_b16 v[46:47], v16 offset:2432
    v_mfma_f32_32x32x16_bf16 v[208:223], v[88:91], v[52:55], v[208:223]
    v_mfma_f32_32x32x16_bf16 v[224:239], v[72:75], v[52:55], v[224:239]
    s_waitcnt lgkmcnt(10)
    v_mfma_f32_32x32x16_bf16 v[192:207], v[132:135], v[56:59], v[192:207]
    ds_read_b64_tr_b16 v[48:49], v16 offset:2592
    ds_read_b64_tr_b16 v[50:51], v16 offset:2560
    v_mfma_f32_32x32x16_bf16 v[208:223], v[84:87], v[56:59], v[208:223]
    v_mfma_f32_32x32x16_bf16 v[224:239], v[68:71], v[56:59], v[224:239]
    s_waitcnt lgkmcnt(10)
    v_mfma_f32_32x32x16_bf16 v[192:207], v[128:131], v[60:63], v[192:207]
    ds_read_b64_tr_b16 v[52:53], v16 offset:2720
    ds_read_b64_tr_b16 v[54:55], v16 offset:2688
    v_mfma_f32_32x32x16_bf16 v[208:223], v[80:83], v[60:63], v[208:223]
    v_mfma_f32_32x32x16_bf16 v[224:239], v[64:67], v[60:63], v[224:239]
    s_waitcnt lgkmcnt(10)
    v_mfma_f32_32x32x16_bf16 v[192:207], v[124:127], v[32:35], v[192:207]
    ds_read_b64_tr_b16 v[56:57], v16 offset:2848
    ds_read_b64_tr_b16 v[58:59], v16 offset:2816
    v_mfma_f32_32x32x16_bf16 v[208:223], v[76:79], v[32:35], v[208:223]
    s_waitcnt lgkmcnt(10)
    v_mfma_f32_32x32x16_bf16 v[192:207], v[120:123], v[36:39], v[192:207]
    ds_read_b64_tr_b16 v[60:61], v16 offset:2976
    ds_read_b64_tr_b16 v[62:63], v16 offset:2944
    v_mfma_f32_32x32x16_bf16 v[208:223], v[72:75], v[36:39], v[208:223]
    s_waitcnt lgkmcnt(10)
    v_mfma_f32_32x32x16_bf16 v[192:207], v[116:119], v[40:43], v[192:207]
    ds_read_b64_tr_b16 v[32:33], v16 offset:3104
    ds_read_b64_tr_b16 v[34:35], v16 offset:3072
    v_mfma_f32_32x32x16_bf16 v[208:223], v[68:71], v[40:43], v[208:223]
    s_waitcnt lgkmcnt(10)
    v_mfma_f32_32x32x16_bf16 v[192:207], v[112:115], v[44:47], v[192:207]
    ds_read_b64_tr_b16 v[36:37], v16 offset:3232
    ds_read_b64_tr_b16 v[38:39], v16 offset:3200
    v_mfma_f32_32x32x16_bf16 v[208:223], v[64:67], v[44:47], v[208:223]
    s_waitcnt lgkmcnt(10)
    v_mfma_f32_32x32x16_bf16 v[192:207], v[108:111], v[48:51], v[192:207]
    ds_read_b64_tr_b16 v[40:41], v16 offset:3360
    ds_read_b64_tr_b16 v[42:43], v16 offset:3328
    s_waitcnt lgkmcnt(10)
    v_mfma_f32_32x32x16_bf16 v[192:207], v[104:107], v[52:55], v[192:207]
    ds_read_b64_tr_b16 v[44:45], v16 offset:3488
    ds_read_b64_tr_b16 v[46:47], v16 offset:3456
    s_waitcnt lgkmcnt(10)
    v_mfma_f32_32x32x16_bf16 v[192:207], v[100:103], v[56:59], v[192:207]
    ds_read_b64_tr_b16 v[48:49], v16 offset:3616
    ds_read_b64_tr_b16 v[50:51], v16 offset:3584
    s_waitcnt lgkmcnt(10)
    v_mfma_f32_32x32x16_bf16 v[192:207], v[96:99], v[60:63], v[192:207]
    ds_read_b64_tr_b16 v[52:53], v16 offset:3744
    ds_read_b64_tr_b16 v[54:55], v16 offset:3712
    s_waitcnt lgkmcnt(10)
    v_mfma_f32_32x32x16_bf16 v[192:207], v[92:95], v[32:35], v[192:207]
    ds_read_b64_tr_b16 v[56:57], v16 offset:3872
    ds_read_b64_tr_b16 v[58:59], v16 offset:3840
    s_waitcnt lgkmcnt(10)
    v_mfma_f32_32x32x16_bf16 v[192:207], v[88:91], v[36:39], v[192:207]
    ds_read_b64_tr_b16 v[60:61], v16 offset:4000
    ds_read_b64_tr_b16 v[62:63], v16 offset:3968
    s_waitcnt lgkmcnt(10)
    v_mfma_f32_32x32x16_bf16 v[192:207], v[84:87], v[40:43], v[192:207]
    s_waitcnt lgkmcnt(8)
    v_mfma_f32_32x32x16_bf16 v[192:207], v[80:83], v[44:47], v[192:207]
    s_waitcnt lgkmcnt(6)
    v_mfma_f32_32x32x16_bf16 v[192:207], v[76:79], v[48:51], v[192:207]
    s_waitcnt lgkmcnt(4)
    v_mfma_f32_32x32x16_bf16 v[192:207], v[72:75], v[52:55], v[192:207]
    s_waitcnt lgkmcnt(2)
    v_mfma_f32_32x32x16_bf16 v[192:207], v[68:71], v[56:59], v[192:207]
    s_waitcnt lgkmcnt(0)
    v_mfma_f32_32x32x16_bf16 v[192:207], v[64:67], v[60:63], v[192:207]
    s_setprio 1
L_tab_A:
    ds_read_b32 v15, v23 offset:4
    s_waitcnt lgkmcnt(0)
    v_readfirstlane_b32 s40, v15
    s_cmp_lt_u32 s40, 4
    s_cbranch_scc1 L_tab_A
    v_and_b32 v14, 3, v0
    v_mul_u32_u24 v14, 16448, v14
    v_add_u32 v14, m0, v14
    ds_write_b128 v14, v[28:31]
    ds_write_addtid_b32 v240 offset:0
    ds_write_addtid_b32 v241 offset:16452
    ds_write_addtid_b32 v242 offset:32904
    ds_write_addtid_b32 v243 offset:49356
    ds_write_addtid_b32 v244 offset:256
    ds_write_addtid_b32 v245 offset:16708
    ds_write_addtid_b32 v246 offset:33160
    ds_write_addtid_b32 v247 offset:49612
    ds_write_addtid_b32 v248 offset:512
    ds_write_addtid_b32 v249 offset:16964
    ds_write_addtid_b32 v250 offset:33416
    ds_write_addtid_b32 v251 offset:49868
    ds_write_addtid_b32 v252 offset:768
    ds_write_addtid_b32 v253 offset:17220
    ds_write_addtid_b32 v254 offset:33672
    ds_write_addtid_b32 v255 offset:50124
    ds_write_addtid_b32 v224 offset:3072
    ds_write_addtid_b32 v225 offset:19524
    ds_write_addtid_b32 v226 offset:35976
    ds_write_addtid_b32 v227 offset:52428
    ds_write_addtid_b32 v228 offset:3328
    ds_write_addtid_b32 v229 offset:19780
    ds_write_addtid_b32 v230 offset:36232
    ds_write_addtid_b32 v231 offset:52684
    ds_write_addtid_b32 v232 offset:3584
    ds_write_addtid_b32 v233 offset:20036
    ds_write_addtid_b32 v234 offset:36488
    ds_write_addtid_b32 v235 offset:52940
    ds_write_addtid_b32 v236 offset:3840
    ds_write_addtid_b32 v237 offset:20292
    ds_write_addtid_b32 v238 offset:36744
    ds_write_addtid_b32 v239 offset:53196
    ds_write_addtid_b32 v208 offset:4096
    ds_write_addtid_b32 v209 offset:20548
    ds_write_addtid_b32 v210 offset:37000
    ds_write_addtid_b32 v211 offset:53452
    ds_write_addtid_b32 v212 offset:4352
    ds_write_addtid_b32 v213 offset:20804
    ds_write_addtid_b32 v214 offset:37256
    ds_write_addtid_b32 v215 offset:53708
    ds_write_addtid_b32 v216 offset:4608
    ds_write_addtid_b32 v217 offset:21060
    ds_write_addtid_b32 v218 offset:37512
    ds_write_addtid_b32 v219 offset:53964
    ds_write_addtid_b32 v220 offset:4864
    ds_write_addtid_b32 v221 offset:21316
    ds_write_addtid_b32 v222 offset:37768
    ds_write_addtid_b32 v223 offset:54220
    ds_write_addtid_b32 v192 offset:7168
    ds_write_addtid_b32 v193 offset:23620
    ds_write_addtid_b32 v194 offset:40072
    ds_write_addtid_b32 v195 offset:56524
    ds_write_addtid_b32 v196 offset:7424
    ds_write_addtid_b32 v197 offset:23876
    ds_write_addtid_b32 v198 offset:40328
    ds_write_addtid_b32 v199 offset:56780
    ds_write_addtid_b32 v200 offset:7680
    ds_write_addtid_b32 v201 offset:24132
    ds_write_addtid_b32 v202 offset:40584
    ds_write_addtid_b32 v203 offset:57036
    ds_write_addtid_b32 v204 offset:7936
    ds_write_addtid_b32 v205 offset:24388
    ds_write_addtid_b32 v206 offset:40840
    ds_write_addtid_b32 v207 offset:57292
    s_branch L_cC
L_cB:
    ds_read_b64_tr_b16 v[32:33], v16 offset:32
    ds_read_b64_tr_b16 v[34:35], v16 offset:0
    ds_read_b128 v[172:175], v17 offset:3456
    ds_read_b128 v[156:159], v17 offset:2944
    ds_read_b128 v[108:111], v17 offset:1408
    ds_read_b128 v[92:95], v17 offset:896
    ds_read_b64_tr_b16 v[36:37], v16 offset:160
    ds_read_b64_tr_b16 v[38:39], v16 offset:128
    ds_read_b128 v[168:171], v17 offset:3328
    ds_read_b128 v[152:155], v17 offset:2816
    ds_read_b128 v[104:107], v17 offset:1280
    ds_read_b128 v[88:91], v17 offset:768
    s_setprio 0
    s_waitcnt lgkmcnt(6)
    v_mfma_f32_32x32x16_bf16 v[192:207], v[172:175], v[32:35], 0
    ds_read_b64_tr_b16 v[40:41], v16 offset:288
    ds_read_b64_tr_b16 v[42:43], v16 offset:256
    v_mfma_f32_32x32x16_bf16 v[208:223], v[156:159], v[32:35], 0
    ds_read_b128 v[164:167], v17 offset:3200
    ds_read_b128 v[148:151], v17 offset:2688
    v_mfma_f32_32x32x16_bf16 v[224:239], v[108:111], v[32:35], 0
    ds_read_b128 v[100:103], v17 offset:1152
    ds_read_b128 v[84:87], v17 offset:640
    v_mfma_f32_32x32x16_bf16 v[240:255], v[92:95], v[32:35], 0
    s_waitcnt lgkmcnt(6)
    v_mfma_f32_32x32x16_bf16 v[192:207], v[168:171], v[36:39], v[192:207]
    ds_read_b64_tr_b16 v[44:45], v16 offset:416
    ds_read_b64_tr_b16 v[46:47], v16 offset:384
    v_mfma_f32_32x32x16_bf16 v[208:223], v[152:155], v[36:39], v[208:223]
    ds_read_b128 v[160:163], v17 offset:3072
    ds_read_b128 v[144:147], v17 offset:2560
    v_mfma_f32_32x32x16_bf16 v[224:239], v[104:107], v[36:39], v[224:239]
    ds_read_b128 v[96:99], v17 offset:1024
    ds_read_b128 v[80:83], v17 offset:512
    v_mfma_f32_32x32x16_bf16 v[240:255], v[88:91], v[36:39], v[240:255]
    s_waitcnt lgkmcnt(6)
    v_mfma_f32_32x32x16_bf16 v[192:207], v[164:167], v[40:43], v[192:207]
    ds_read_b64_tr_b16 v[48:49], v16 offset:544
    ds_read_b64_tr_b16 v[50:51], v16 offset:512
    v_mfma_f32_32x32x16_bf16 v[208:223], v[148:151], v[40:43], v[208:223]
    ds_read_b128 v[140:143], v17 offset:2432
    ds_read_b128 v[76:79], v17 offset:384
    v_mfma_f32_32x32x16_bf16 v[224:239], v[100:103], v[40:43], v[224:239]
    ds_read_b64_tr_b16 v[52:53], v16 offset:672
    ds_read_b64_tr_b16 v[54:55], v16 offset:640
    v_mfma_f32_32x32x16_bf16 v[240:255], v[84:87], v[40:43], v[240:255]
    s_waitcnt lgkmcnt(6)
    v_mfma_f32_32x32x16_bf16 v[192:207], v[160:163], v[44:47], v[192:207]
    ds_read_b128 v[136:139], v17 offset:2304
    ds_read_b128 v[72:75], v17 offset:256
    v_mfma_f32_32x32x16_bf16 v[208:223], v[144:147], v[44:47], v[208:223]
    ds_read_b64_tr_b16 v[56:57], v16 offset:800
    ds_read_b64_tr_b16 v[58:59], v16 offset:768
    v_mfma_f32_32x32x16_bf16 v[224:239], v[96:99], v[44:47], v[224:239]
    ds_read_b128 v[132:135], v17 offset:2176
    ds_read_b128 v[68:71], v17 offset:128
    v_mfma_f32_32x32x16_bf16 v[240:255], v[80:83], v[44:47], v[240:255]
    s_waitcnt lgkmcnt(8)
    v_mfma_f32_32x32x16_bf16 v[192:207], v[156:159], v[48:51], v[192:207]
    ds_read_b64_tr_b16 v[60:61], v16 offset:928
    ds_read_b64_tr_b16 v[62:63], v16 offset:896
    v_mfma_f32_32x32x16_bf16 v[208:223], v[140:143], v[48:51], v[208:223]
    ds_read_b128 v[128:131], v17 offset:2048
    ds_read_b128 v[64:67], v17 offset:0
    v_mfma_f32_32x32x16_bf16 v[224:239], v[92:95], v[48:51], v[224:239]
    v_mfma_f32_32x32x16_bf16 v[240:255], v[76:79], v[48:51], v[240:255]
    s_waitcnt lgkmcnt(8)
    v_mfma_f32_32x32x16_bf16 v[192:207], v[152:155], v[52:55], v[192:207]
    ds_read_b64_tr_b16 v[32:33], v16 offset:1056
    ds_read_b64_tr_b16 v[34:35], v16 offset:1024
    v_mfma_f32_32x32x16_bf16 v[208:223], v[136:139], v[52:55], v[208:223]
    ds_read_b128 v[124:127], v17 offset:1920
    ds_read_b64_tr_b16 v[36:37], v16 offset:1184
    v_mfma_f32_32x32x16_bf16 v[224:239], v[88:91], v[52:55], v[224:239]
    v_mfma_f32_32x32x16_bf16 v[240:255], v[72:75], v[52:55], v[240:255]
    s_waitcnt lgkmcnt(8)
    v_mfma_f32_32x32x16_bf16 v[192:207], v[148:151], v[56:59], v[192:207]
    ds_read_b64_tr_b16 v[38:39], v16 offset:1152
    ds_read_b128 v[120:123], v17 offset:1792
    v_mfma_f32_32x32x16_bf16 v[208:223], v[132:135], v[56:59], v[208:223]
    ds_read_b64_tr_b16 v[40:41], v16 offset:1312
    ds_read_b64_tr_b16 v[42:43], v16 offset:1280
    v_mfma_f32_32x32x16_bf16 v[224:239], v[84:87], v[56:59], v[224:239]
    v_mfma_f32_32x32x16_bf16 v[240:255], v[68:71], v[56:59], v[240:255]
    s_waitcnt lgkmcnt(8)
    v_mfma_f32_32x32x16_bf16 v[192:207], v[144:147], v[60:63], v[192:207]
    ds_read_b128 v[116:119], v17 offset:1664
    ds_read_b64_tr_b16 v[44:45], v16 offset:1440
    v_mfma_f32_32x32x16_bf16 v[208:223], v[128:131], v[60:63], v[208:223]
    ds_read_b64_tr_b16 v[46:47], v16 offset:1408
    ds_read_b128 v[112:115], v17 offset:1536
    v_mfma_f32_32x32x16_bf16 v[224:239], v[80:83], v[60:63], v[224:239]
    v_mfma_f32_32x32x16_bf16 v[240:255], v[64:67], v[60:63], v[240:255]
    s_waitcnt lgkmcnt(9)
    v_mfma_f32_32x32x16_bf16 v[192:207], v[140:143], v[32:35], v[192:207]
    ds_read_b64_tr_b16 v[48:49], v16 offset:1568
    ds_read_b64_tr_b16 v[50:51], v16 offset:1536
    v_mfma_f32_32x32x16_bf16 v[208:223], v[124:127], v[32:35], v[208:223]
    ds_read_b64_tr_b16 v[52:53], v16 offset:1696
    v_mfma_f32_32x32x16_bf16 v[224:239], v[76:79], v[32:35], v[224:239]
    s_waitcnt lgkmcnt(9)
    v_mfma_f32_32x32x16_bf16 v[192:207], v[136:139], v[36:39], v[192:207]
    ds_read_b64_tr_b16 v[54:55], v16 offset:1664
    ds_read_b64_tr_b16 v[56:57], v16 offset:1824
    v_mfma_f32_32x32x16_bf16 v[208:223], v[120:123], v[36:39], v[208:223]
    ds_read_b64_tr_b16 v[58:59], v16 offset:1792
    v_mfma_f32_32x32x16_bf16 v[224:239], v[72:75], v[36:39], v[224:239]
    s_waitcnt lgkmcnt(9)
    v_mfma_f32_32x32x16_bf16 v[192:207], v[132:135], v[40:43], v[192:207]
    ds_read_b64_tr_b16 v[60:61], v16 offset:1952
    ds_read_b64_tr_b16 v[62:63], v16 offset:1920
    v_mfma_f32_32x32x16_bf16 v[208:223], v[116:119], v[40:43], v[208:223]
    ds_read_b64_tr_b16 v[32:33], v16 offset:2080
    v_mfma_f32_32x32x16_bf16 v[224:239], v[68:71], v[40:43], v[224:239]
    s_waitcnt lgkmcnt(9)
    v_mfma_f32_32x32x16_bf16 v[192:207], v[128:131], v[44:47], v[192:207]
    ds_read_b64_tr_b16 v[34:35], v16 offset:2048
    ds_read_b64_tr_b16 v[36:37], v16 offset:2208
    v_mfma_f32_32x32x16_bf16 v[208:223], v[112:115], v[44:47], v[208:223]
    ds_read_b64_tr_b16 v[38:39], v16 offset:2176
    v_mfma_f32_32x32x16_bf16 v[224:239], v[64:67], v[44:47], v[224:239]
    s_waitcnt lgkmcnt(10)
    v_mfma_f32_32x32x16_bf16 v[192:207], v[124:127], v[48:51], v[192:207]
    ds_read_b64_tr_b16 v[40:41], v16 offset:2336
    ds_read_b64_tr_b16 v[42:43], v16 offset:2304
    v_mfma_f32_32x32x16_bf16 v[208:223], v[108:111], v[48:51], v[208:223]
    s_waitcnt lgkmcnt(10)
    v_mfma_f32_32x32x16_bf16 v[192:207], v[120:123], v[52:55], v[192:207]
    ds_read_b64_tr_b16 v[44:45], v16 offset:2464
    ds_read_b64_tr_b16 v[46:47], v16 offset:2432
    v_mfma_f32_32x32x16_bf16 v[208:223], v[104:107], v[52:55], v[208:223]
    s_waitcnt lgkmcnt(10)
    v_mfma_f32_32x32x16_bf16 v[192:207], v[116:119], v[56:59], v[192:207]
    ds_read_b64_tr_b16 v[48:49], v16 offset:2592
    ds_read_b64_tr_b16 v[50:51], v16 offset:2560
    v_mfma_f32_32x32x16_bf16 v[208:223], v[100:103], v[56:59], v[208:223]
    s_waitcnt lgkmcnt(10)
    v_mfma_f32_32x32x16_bf16 v[192:207], v[112:115], v[60:63], v[192:207]
    ds_read_b64_tr_b16 v[52:53], v16 offset:2720
    ds_read_b64_tr_b16 v[54:55], v16 offset:2688
    v_mfma_f32_32x32x16_bf16 v[208:223], v[96:99], v[60:63], v[208:223]
    s_waitcnt lgkmcnt(10)
    v_mfma_f32_32x32x16_bf16 v[192:207], v[108:111], v[32:35], v[192:207]
    ds_read_b64_tr_b16 v[56:57], v16 offset:2848
    ds_read_b64_tr_b16 v[58:59], v16 offset:2816
    v_mfma_f32_32x32x16_bf16 v[208:223], v[92:95], v[32:35], v[208:223]
    s_waitcnt lgkmcnt(10)
    v_mfma_f32_32x32x16_bf16 v[192:207], v[104:107], v[36:39], v[192:207]
    ds_read_b64_tr_b16 v[60:61], v16 offset:2976
    ds_read_b64_tr_b16 v[62:63], v16 offset:2944
    v_mfma_f32_32x32x16_bf16 v[208:223], v[88:91], v[36:39], v[208:223]
    s_waitcnt lgkmcnt(10)
    v_mfma_f32_32x32x16_bf16 v[192:207], v[100:103], v[40:43], v[192:207]
    ds_read_b64_tr_b16 v[32:33], v16 offset:3104
    ds_read_b64_tr_b16 v[34:35], v16 offset:3072
    v_mfma_f32_32x32x16_bf16 v[208:223], v[84:87], v[40:43], v[208:223]
    s_waitcnt lgkmcnt(10)
    v_mfma_f32_32x32x16_bf16 v[192:207], v[96:99], v[44:47], v[192:207]
    ds_read_b64_tr_b16 v[36:37], v16 offset:3232
    ds_read_b64_tr_b16 v[38:39], v16 offset:3200
    v_mfma_f32_32x32x16_bf16 v[208:223], v[80:83], v[44:47], v[208:223]
    s_waitcnt lgkmcnt(10)
    v_mfma_f32_32x32x16_bf16 v[192:207], v[92:95], v[48:51], v[192:207]
    ds_read_b64_tr_b16 v[40:41], v16 offset:3360
    ds_read_b64_tr_b16 v[42:43], v16 offset:3328
    v_mfma_f32_32x32x16_bf16 v[208:223], v[76:79], v[48:51], v[208:223]
    s_waitcnt lgkmcnt(10)
    v_mfma_f32_32x32x16_bf16 v[192:207], v[88:91], v[52:55], v[192:207]
    ds_read_b64_tr_b16 v[44:45], v16 offset:3488
    ds_read_b64_tr_b16 v[46:47], v16 offset:3456
    v_mfma_f32_32x32x16_bf16 v[208:223], v[72:75], v[52:55], v[208:223]
    s_waitcnt lgkmcnt(10)
    v_mfma_f32_32x32x16_bf16 v[192:207], v[84:87], v[56:59], v[192:207]
    v_mfma_f32_32x32x16_bf16 v[208:223], v[68:71], v[56:59], v[208:223]
    s_waitcnt lgkmcnt(8)
    v_mfma_f32_32x32x16_bf16 v[192:207], v[80:83], v[60:63], v[192:207]
    v_mfma_f32_32x32x16_bf16 v[208:223], v[64:67], v[60:63], v[208:223]
    s_waitcnt lgkmcnt(6)
    v_mfma_f32_32x32x16_bf16 v[192:207], v[76:79], v[32:35], v[192:207]
    s_waitcnt lgkmcnt(4)
    v_mfma_f32_32x32x16_bf16 v[192:207], v[72:75], v[36:39], v[192:207]
    s_waitcnt lgkmcnt(2)
    v_mfma_f32_32x32x16_bf16 v[192:207], v[68:71], v[40:43], v[192:207]
    s_waitcnt lgkmcnt(0)
    v_mfma_f32_32x32x16_bf16 v[192:207], v[64:67], v[44:47], v[192:207]
    s_setprio 1
L_tab_B:
    ds_read_b32 v15, v23 offset:4
    s_waitcnt lgkmcnt(0)
    v_readfirstlane_b32 s40, v15
    s_cmp_lt_u32 s40, 4
    s_cbranch_scc1 L_tab_B
    ds_write_addtid_b32 v240 offset:1024
    ds_write_addtid_b32 v241 offset:17476
    ds_write_addtid_b32 v242 offset:33928
    ds_write_addtid_b32 v243 offset:50380
    ds_write_addtid_b32 v244 offset:1280
    ds_write_addtid_b32 v245 offset:17732
    ds_write_addtid_b32 v246 offset:34184
    ds_write_addtid_b32 v247 offset:50636
    ds_write_addtid_b32 v248 offset:1536
    ds_write_addtid_b32 v249 offset:17988
    ds_write_addtid_b32 v250 offset:34440
    ds_write_addtid_b32 v251 offset:50892
    ds_write_addtid_b32 v252 offset:1792
    ds_write_addtid_b32 v253 offset:18244
    ds_write_addtid_b32 v254 offset:34696
    ds_write_addtid_b32 v255 offset:51148
    ds_write_addtid_b32 v224 offset:2048
    ds_write_addtid_b32 v225 offset:18500
    ds_write_addtid_b32 v226 offset:34952
    ds_write_addtid_b32 v227 offset:51404
    ds_write_addtid_b32 v228 offset:2304
    ds_write_addtid_b32 v229 offset:18756
    ds_write_addtid_b32 v230 offset:35208
    ds_write_addtid_b32 v231 offset:51660
    ds_write_addtid_b32 v232 offset:2560
    ds_write_addtid_b32 v233 offset:19012
    ds_write_addtid_b32 v234 offset:35464
    ds_write_addtid_b32 v235 offset:51916
    ds_write_addtid_b32 v236 offset:2816
    ds_write_addtid_b32 v237 offset:19268
    ds_write_addtid_b32 v238 offset:35720
    ds_write_addtid_b32 v239 offset:52172
    ds_write_addtid_b32 v208 offset:5120
    ds_write_addtid_b32 v209 offset:21572
    ds_write_addtid_b32 v210 offset:38024
    ds_write_addtid_b32 v211 offset:54476
    ds_write_addtid_b32 v212 offset:5376
    ds_write_addtid_b32 v213 offset:21828
    ds_write_addtid_b32 v214 offset:38280
    ds_write_addtid_b32 v215 offset:54732
    ds_write_addtid_b32 v216 offset:5632
    ds_write_addtid_b32 v217 offset:22084
    ds_write_addtid_b32 v218 offset:38536
    ds_write_addtid_b32 v219 offset:54988
    ds_write_addtid_b32 v220 offset:5888
    ds_write_addtid_b32 v221 offset:22340
    ds_write_addtid_b32 v222 offset:38792
    ds_write_addtid_b32 v223 offset:55244
    ds_write_addtid_b32 v192 offset:6144
    ds_write_addtid_b32 v193 offset:22596
    ds_write_addtid_b32 v194 offset:39048
    ds_write_addtid_b32 v195 offset:55500
    ds_write_addtid_b32 v196 offset:6400
    ds_write_addtid_b32 v197 offset:22852
    ds_write_addtid_b32 v198 offset:39304
    ds_write_addtid_b32 v199 offset:55756
    ds_write_addtid_b32 v200 offset:6656
    ds_write_addtid_b32 v201 offset:23108
    ds_write_addtid_b32 v202 offset:39560
    ds_write_addtid_b32 v203 offset:56012
    ds_write_addtid_b32 v204 offset:6912
    ds_write_addtid_b32 v205 offset:23364
    ds_write_addtid_b32 v206 offset:39816
    ds_write_addtid_b32 v207 offset:56268
L_cC:
    v_mov_b32 v15, 1
    s_waitcnt lgkmcnt(0)
    s_mov_b64 exec, 1
    ds_add_u32 v23, v15 offset:8
    s_mov_b64 exec, -1
L_spin_c:
    ds_read_b32 v15, v23 offset:8
    s_waitcnt lgkmcnt(0)
    v_readfirstlane_b32 s40, v15
    s_cmp_lt_u32 s40, 4
    s_cbranch_scc1 L_spin_c
    ds_read_b128 v[192:195], v21 offset:0
    ds_read_b128 v[196:199], v21 offset:8224
    ds_read_b128 v[200:203], v21 offset:16448
    ds_read_b128 v[204:207], v21 offset:24672
    ds_read_b128 v[208:211], v21 offset:32896
    ds_read_b128 v[212:215], v21 offset:41120
    ds_read_b128 v[216:219], v21 offset:49344
    ds_read_b128 v[220:223], v21 offset:57568
    ds_read_b128 v[224:227], v21 offset:1024
    ds_read_b128 v[228:231], v21 offset:9248
    ds_read_b128 v[232:235], v21 offset:17472
    ds_read_b128 v[236:239], v21 offset:25696
    ds_read_b128 v[240:243], v21 offset:33920
    ds_read_b128 v[244:247], v21 offset:42144
    ds_read_b128 v[248:251], v21 offset:50368
    ds_read_b128 v[252:255], v21 offset:58592
    s_waitcnt lgkmcnt(8)
    v_pk_add_f32 v[192:193], v[192:193], v[200:201]
    v_pk_add_f32 v[208:209], v[208:209], v[216:217]
    v_pk_add_f32 v[194:195], v[194:195], v[202:203]
    v_pk_add_f32 v[210:211], v[210:211], v[218:219]
    v_pk_add_f32 v[196:197], v[196:197], v[204:205]
    v_pk_add_f32 v[212:213], v[212:213], v[220:221]
    v_pk_add_f32 v[198:199], v[198:199], v[206:207]
    v_pk_add_f32 v[214:215], v[214:215], v[222:223]
    v_pk_add_f32 v[192:193], v[192:193], v[208:209]
    v_pk_add_f32 v[194:195], v[194:195], v[210:211]
    v_pk_add_f32 v[196:197], v[196:197], v[212:213]
    v_pk_add_f32 v[198:199], v[198:199], v[214:215]
    v_cvt_pk_bf16_f32 v192, v192, v196
    v_cvt_pk_bf16_f32 v193, v193, v197
    v_cvt_pk_bf16_f32 v194, v194, v198
    v_cvt_pk_bf16_f32 v195, v195, v199
    s_waitcnt lgkmcnt(0)
    v_pk_add_f32 v[224:225], v[224:225], v[232:233]
    v_pk_add_f32 v[240:241], v[240:241], v[248:249]
    v_pk_add_f32 v[226:227], v[226:227], v[234:235]
    v_pk_add_f32 v[242:243], v[242:243], v[250:251]
    v_pk_add_f32 v[228:229], v[228:229], v[236:237]
    v_pk_add_f32 v[244:245], v[244:245], v[252:253]
    v_pk_add_f32 v[230:231], v[230:231], v[238:239]
    v_pk_add_f32 v[246:247], v[246:247], v[254:255]
    v_pk_add_f32 v[224:225], v[224:225], v[240:241]
    v_pk_add_f32 v[226:227], v[226:227], v[242:243]
    v_pk_add_f32 v[228:229], v[228:229], v[244:245]
    v_pk_add_f32 v[230:231], v[230:231], v[246:247]
    v_cvt_pk_bf16_f32 v224, v224, v228
    v_cvt_pk_bf16_f32 v225, v225, v229
    v_cvt_pk_bf16_f32 v226, v226, v230
    v_cvt_pk_bf16_f32 v227, v227, v231
L_wait_b:
    ds_read_b32 v15, v23 offset:20
    s_waitcnt lgkmcnt(0)
    v_readfirstlane_b32 s40, v15
    s_cmp_lg_u32 s40, 0
    s_cbranch_scc1 L_go_b
    s_sleep 4
    s_branch L_wait_b
L_go_b:
    buffer_store_dwordx4 v[192:195], v21, s[36:39], s12 offen offset:0 sc1
    buffer_store_dwordx4 v[224:227], v21, s[36:39], s12 offen offset:1024 sc1
    v_mov_b32 v15, 1
    s_waitcnt lgkmcnt(0)
    s_mov_b64 exec, 1
    ds_add_u32 v23, v15 offset:12
    s_mov_b64 exec, -1
L_spin_d:
    ds_read_b32 v15, v23 offset:12
    s_waitcnt lgkmcnt(0)
    v_readfirstlane_b32 s40, v15
    s_cmp_lt_u32 s40, 4
    s_cbranch_scc1 L_spin_d
L_p3:
    s_mov_b32 s12, 0
L_wait_at:
    ds_read_b32 v15, v23 offset:20
    s_waitcnt lgkmcnt(0)
    v_readfirstlane_b32 s40, v15
    s_cmp_lg_u32 s40, 0
    s_cbranch_scc1 L_go_at
    s_sleep 8
    s_branch L_wait_at
L_go_at:
    s_mov_b32 m0, s45
    s_nop 0
    buffer_load_dwordx4 v3, s[28:31], s12 offen lds
    s_add_u32 s12, s12, 14336
    s_add_u32 m0, m0, 4096
    s_waitcnt vmcnt(3)
    buffer_load_dwordx4 v3, s[28:31], s12 offen lds
    s_add_u32 s12, s12, 14336
    s_add_u32 m0, m0, 4096
    s_waitcnt vmcnt(3)
    buffer_load_dwordx4 v3, s[28:31], s12 offen lds
    s_add_u32 s12, s12, 14336
    s_add_u32 m0, m0, 4096
    s_waitcnt vmcnt(3)
    buffer_load_dwordx4 v3, s[28:31], s12 offen lds
    s_add_u32 s12, s12, 14336
    s_add_u32 m0, m0, 4096
    s_waitcnt vmcnt(3)
    s_mov_b64 exec, 1
    global_atomic_add v22, v1, s[60:61] sc1
    s_mov_b64 exec, -1
    buffer_load_dwordx4 v3, s[28:31], s12 offen lds
    s_add_u32 s12, s12, 14336
    s_add_u32 m0, m0, 4096
    s_waitcnt vmcnt(3)
    buffer_load_dwordx4 v3, s[28:31], s12 offen lds
    s_add_u32 s12, s12, 14336
    s_add_u32 m0, m0, 4096
    s_waitcnt vmcnt(3)
    buffer_load_dwordx4 v3, s[28:31], s12 offen lds
    s_add_u32 s12, s12, 14336
    s_add_u32 m0, m0, 4096
    s_waitcnt vmcnt(3)
    buffer_load_dwordx4 v3, s[28:31], s12 offen lds
    s_add_u32 s12, s12, 14336
    s_add_u32 m0, m0, 4096
    s_waitcnt vmcnt(3)
    buffer_load_dwordx4 v3, s[28:31], s12 offen lds
    s_add_u32 s12, s12, 14336
    s_add_u32 m0, m0, 4096
    s_waitcnt vmcnt(3)
    buffer_load_dwordx4 v3, s[28:31], s12 offen lds
    s_add_u32 s12, s12, 14336
    s_add_u32 m0, m0, 4096
    s_waitcnt vmcnt(3)
    buffer_load_dwordx4 v3, s[28:31], s12 offen lds
    s_add_u32 s12, s12, 14336
    s_add_u32 m0, m0, 4096
    s_waitcnt vmcnt(3)
    buffer_load_dwordx4 v3, s[28:31], s12 offen lds
    s_add_u32 s12, s12, 14336
    s_add_u32 m0, m0, 4096
    s_waitcnt vmcnt(3)
    buffer_load_dwordx4 v3, s[28:31], s12 offen lds
    s_add_u32 s12, s12, 14336
    s_add_u32 m0, m0, 4096
    s_waitcnt vmcnt(3)
    buffer_load_dwordx4 v3, s[28:31], s12 offen lds
    s_add_u32 s12, s12, 14336
    v_mov_b32 v15, 1
    s_waitcnt vmcnt(0) lgkmcnt(0)
    s_mov_b64 exec, 1
    ds_add_u32 v23, v15 offset:32
    s_mov_b64 exec, -1
L_spin_w0:
    ds_read_b32 v15, v23 offset:32
    s_waitcnt lgkmcnt(0)
    v_readfirstlane_b32 s40, v15
    s_cmp_lt_u32 s40, 4
    s_cbranch_scc1 L_spin_w0
    ds_read_b64_tr_b16 v[32:33], v8 offset:0
    ds_read_b64_tr_b16 v[34:35], v8 offset:1024
    ds_read_b64_tr_b16 v[36:37], v9 offset:4096
    ds_read_b64_tr_b16 v[38:39], v9 offset:5120
    ds_read_b64_tr_b16 v[40:41], v8 offset:10240
    ds_read_b64_tr_b16 v[42:43], v8 offset:11264
    ds_read_b64_tr_b16 v[44:45], v8 offset:14336
    ds_read_b64_tr_b16 v[46:47], v8 offset:15360
    ds_read_b64_tr_b16 v[48:49], v9 offset:18432
    ds_read_b64_tr_b16 v[50:51], v9 offset:19456
    ds_read_b64_tr_b16 v[52:53], v8 offset:24576
    ds_read_b64_tr_b16 v[54:55], v8 offset:25600
    ds_read_b64_tr_b16 v[56:57], v10 offset:6144
    ds_read_b64_tr_b16 v[58:59], v10 offset:7168
    ds_read_b64_tr_b16 v[60:61], v8 offset:28672
    ds_read_b64_tr_b16 v[62:63], v8 offset:29696
    ds_read_b64_tr_b16 v[64:65], v9 offset:32768
    ds_read_b64_tr_b16 v[66:67], v9 offset:33792
    ds_read_b64_tr_b16 v[68:69], v8 offset:38912
    ds_read_b64_tr_b16 v[70:71], v8 offset:39936
    ds_read_b64_tr_b16 v[72:73], v8 offset:43008
    ds_read_b64_tr_b16 v[74:75], v8 offset:44032
    ds_read_b64_tr_b16 v[76:77], v9 offset:47104
    ds_read_b64_tr_b16 v[78:79], v9 offset:48128
    ds_read_b64_tr_b16 v[80:81], v8 offset:53248
    ds_read_b64_tr_b16 v[82:83], v8 offset:54272
    ds_read_b64_tr_b16 v[84:85], v10 offset:34816
    ds_read_b64_tr_b16 v[86:87], v10 offset:35840
    v_mov_b32 v15, 1
    s_waitcnt lgkmcnt(0)
    s_mov_b64 exec, 1
    ds_add_u32 v23, v15 offset:36
    s_mov_b64 exec, -1
L_spin_wx:
    ds_read_b32 v15, v23 offset:36
    s_waitcnt lgkmcnt(0)
    v_readfirstlane_b32 s40, v15
    s_cmp_lt_u32 s40, 4
    s_cbranch_scc1 L_spin_wx
    s_mov_b32 m0, s45
    s_nop 0
    buffer_load_dwordx4 v3, s[28:31], s12 offen lds
    s_add_u32 s12, s12, 14336
    s_add_u32 m0, m0, 4096
    s_waitcnt vmcnt(3)
    buffer_load_dwordx4 v3, s[28:31], s12 offen lds
    s_add_u32 s12, s12, 14336
    s_add_u32 m0, m0, 4096
    s_waitcnt vmcnt(3)
    buffer_load_dwordx4 v3, s[28:31], s12 offen lds
    s_add_u32 s12, s12, 14336
    s_add_u32 m0, m0, 4096
    s_waitcnt vmcnt(3)
    buffer_load_dwordx4 v3, s[28:31], s12 offen lds
    s_add_u32 s12, s12, 14336
    s_add_u32 m0, m0, 4096
    s_waitcnt vmcnt(3)
    buffer_load_dwordx4 v3, s[28:31], s12 offen lds
    s_add_u32 s12, s12, 14336
    s_add_u32 m0, m0, 4096
    s_waitcnt vmcnt(3)
    buffer_load_dwordx4 v3, s[28:31], s12 offen lds
    s_add_u32 s12, s12, 14336
    s_add_u32 m0, m0, 4096
    s_waitcnt vmcnt(3)
    buffer_load_dwordx4 v3, s[28:31], s12 offen lds
    s_add_u32 s12, s12, 14336
    s_add_u32 m0, m0, 4096
    s_waitcnt vmcnt(3)
    buffer_load_dwordx4 v3, s[28:31], s12 offen lds
    s_add_u32 s12, s12, 14336
    s_add_u32 m0, m0, 4096
    s_waitcnt vmcnt(3)
    buffer_load_dwordx4 v3, s[28:31], s12 offen lds
    s_add_u32 s12, s12, 14336
    s_add_u32 m0, m0, 4096
    s_waitcnt vmcnt(3)
    buffer_load_dwordx4 v3, s[28:31], s12 offen lds
    s_add_u32 s12, s12, 14336
    s_add_u32 m0, m0, 4096
    s_waitcnt vmcnt(3)
    buffer_load_dwordx4 v3, s[28:31], s12 offen lds
    s_add_u32 s12, s12, 14336
    s_add_u32 m0, m0, 4096
    s_waitcnt vmcnt(3)
    buffer_load_dwordx4 v3, s[28:31], s12 offen lds
    s_add_u32 s12, s12, 14336
    s_add_u32 m0, m0, 4096
    s_waitcnt vmcnt(3)
    buffer_load_dwordx4 v3, s[28:31], s12 offen lds
    s_add_u32 s12, s12, 14336
    s_add_u32 m0, m0, 4096
    s_waitcnt vmcnt(3)
    buffer_load_dwordx4 v3, s[28:31], s12 offen lds
    s_add_u32 s12, s12, 14336
    v_mov_b32 v15, 1
    s_waitcnt vmcnt(0) lgkmcnt(0)
    s_mov_b64 exec, 1
    ds_add_u32 v23, v15 offset:40
    s_mov_b64 exec, -1
L_spin_w1:
    ds_read_b32 v15, v23 offset:40
    s_waitcnt lgkmcnt(0)
    v_readfirstlane_b32 s40, v15
    s_cmp_lt_u32 s40, 4
    s_cbranch_scc1 L_spin_w1
    ds_read_b64_tr_b16 v[88:89], v8 offset:0
    ds_read_b64_tr_b16 v[90:91], v8 offset:1024
    ds_read_b64_tr_b16 v[92:93], v9 offset:4096
    ds_read_b64_tr_b16 v[94:95], v9 offset:5120
    ds_read_b64_tr_b16 v[96:97], v8 offset:10240
    ds_read_b64_tr_b16 v[98:99], v8 offset:11264
    ds_read_b64_tr_b16 v[100:101], v8 offset:14336
    ds_read_b64_tr_b16 v[102:103], v8 offset:15360
    ds_read_b64_tr_b16 v[104:105], v9 offset:18432
    ds_read_b64_tr_b16 v[106:107], v9 offset:19456
    ds_read_b64_tr_b16 v[108:109], v8 offset:24576
    ds_read_b64_tr_b16 v[110:111], v8 offset:25600
    ds_read_b64_tr_b16 v[112:113], v10 offset:6144
    ds_read_b64_tr_b16 v[114:115], v10 offset:7168
    ds_read_b64_tr_b16 v[116:117], v8 offset:28672
    ds_read_b64_tr_b16 v[118:119], v8 offset:29696
    ds_read_b64_tr_b16 v[120:121], v9 offset:32768
    ds_read_b64_tr_b16 v[122:123], v9 offset:33792
    ds_read_b64_tr_b16 v[124:125], v8 offset:38912
    ds_read_b64_tr_b16 v[126:127], v8 offset:39936
    ds_read_b64_tr_b16 v[128:129], v8 offset:43008
    ds_read_b64_tr_b16 v[130:131], v8 offset:44032
    ds_read_b64_tr_b16 v[132:133], v9 offset:47104
    ds_read_b64_tr_b16 v[134:135], v9 offset:48128
    ds_read_b64_tr_b16 v[136:137], v8 offset:53248
    ds_read_b64_tr_b16 v[138:139], v8 offset:54272
    ds_read_b64_tr_b16 v[140:141], v10 offset:34816
    ds_read_b64_tr_b16 v[142:143], v10 offset:35840
    s_cmp_ge_u32 s10, 14
    s_cbranch_scc1 L_nowo
    s_mov_b64 exec, 1
    v_mov_b32 v15, 0
    s_mov_b32 s40, 0
    s_branch L_poll1_b
L_poll_b:
    s_sleep 16
L_poll1_b:
    global_atomic_add v14, v11, v15, s[60:61] sc0 sc1
    s_add_u32 s40, s40, 1
    s_cmp_ge_u32 s40, 65536
    s_cbranch_scc1 L_give_b
    s_waitcnt vmcnt(0)
    v_cmp_ne_u32 vcc, 22, v14
    s_cbranch_vccnz L_poll_b
L_ok_b:
    s_mov_b64 exec, -1
    s_lshl_b32 s40, s10, 17
    s_lshl_b32 s41, s8, 7
    s_add_u32 s40, s40, s41
    s_add_u32 s40, s40, 14680064
    s_add_u32 s41, s41, 10485760
    buffer_load_dword v216, v12, s[36:39], s41 offen sc1
    s_add_u32 s42, s40, 0
    buffer_load_dword v208, v13, s[36:39], s42 offen sc1
    s_add_u32 s42, s40, 8192
    buffer_load_dword v209, v13, s[36:39], s42 offen sc1
    s_add_u32 s42, s40, 16384
    buffer_load_dword v210, v13, s[36:39], s42 offen sc1
    s_add_u32 s42, s40, 24576
    buffer_load_dword v211, v13, s[36:39], s42 offen sc1
    s_add_u32 s42, s40, 65536
    buffer_load_dword v212, v13, s[36:39], s42 offen sc1
    s_add_u32 s42, s40, 73728
    buffer_load_dword v213, v13, s[36:39], s42 offen sc1
    s_add_u32 s42, s40, 81920
    buffer_load_dword v214, v13, s[36:39], s42 offen sc1
    s_add_u32 s42, s40, 90112
    buffer_load_dword v215, v13, s[36:39], s42 offen sc1
L_nowo:
    s_waitcnt vmcnt(0) lgkmcnt(0)
    s_barrier
    s_setprio 0
    s_lshl_b32 s43, s50, 11
    s_add_u32 s43, s43, 32768
    v_bfe_u32 v10, v0, 1, 2
    v_xor_b32 v9, v5, v10
    v_lshl_add_u32 v13, v4, 6, s43
    v_lshl_add_u32 v9, v9, 4, v13
    v_xor_b32 v3, 32, v9
    v_lshrrev_b32 v13, 2, v0
    v_and_b32 v10, 3, v0
    v_mul_u32_u24 v12, 896, v13
    v_lshl_add_u32 v12, v10, 4, v12
    v_bfe_u32 v11, v0, 3, 2
    v_xor_b32 v10, v10, v11
    v_lshl_add_u32 v13, v13, 6, s43
    v_lshl_add_u32 v10, v10, 4, v13
    v_add_u32 v13, 14336, v12
    s_mul_i32 s40, s8, 28672
    s_lshl_b32 s41, s10, 6
    s_add_u32 s40, s40, s41
    s_add_u32 s96, s96, s40
    s_addc_u32 s97, s97, 0
    v_lshlrev_b32 v2, 4, v0
    v_lshl_add_u32 v16, v5, 10, v2
    v_mul_u32_u24 v17, 3584, v5
    v_add_u32 v17, v17, v2
    s_lshl_b32 s40, s8, 8
    s_add_u32 s40, s40, 4
    v_mov_b32 v8, s40
    s_lshl_b32 s12, s8, 15
    s_add_u32 s12, s12, 12582912
    s_add_u32 s12, s12, s45
    s_mov_b32 m0, s45
    v_sub_f32 v217, 1.0, v216
    v_cvt_pk_bf16_f32 v217, v217, v217
    v_and_b32 v217, 0xffff0000, v217
    v_lshlrev_b32 v192, 16, v208
    v_and_b32 v193, 0xffff0000, v208
    v_lshlrev_b32 v194, 16, v209
    v_and_b32 v195, 0xffff0000, v209
    v_lshlrev_b32 v196, 16, v210
    v_and_b32 v197, 0xffff0000, v210
    v_lshlrev_b32 v198, 16, v211
    v_and_b32 v199, 0xffff0000, v211
    v_lshlrev_b32 v200, 16, v212
    v_and_b32 v201, 0xffff0000, v212
    v_lshlrev_b32 v202, 16, v213
    v_and_b32 v203, 0xffff0000, v213
    v_lshlrev_b32 v204, 16, v214
    v_and_b32 v205, 0xffff0000, v214
    v_lshlrev_b32 v206, 16, v215
    v_and_b32 v207, 0xffff0000, v215
    v_mul_f32 v192, v192, v217
    v_mul_f32 v193, v193, v217
    v_mul_f32 v194, v194, v217
    v_mul_f32 v195, v195, v217
    v_mul_f32 v196, v196, v217
    v_mul_f32 v197, v197, v217
    v_mul_f32 v198, v198, v217
    v_mul_f32 v199, v199, v217
    v_mul_f32 v200, v200, v217
    v_mul_f32 v201, v201, v217
    v_mul_f32 v202, v202, v217
    v_mul_f32 v203, v203, v217
    v_mul_f32 v204, v204, v217
    v_mul_f32 v205, v205, v217
    v_mul_f32 v206, v206, v217
    v_mul_f32 v207, v207, v217
    s_cmp_lg_u32 s50, 0
    s_cbranch_scc1 L_ok_o
    s_mov_b64 exec, 1
    v_mov_b32 v15, 0
    s_mov_b32 s40, 0
L_poll_o:
L_poll1_o:
    global_atomic_add v14, v8, v15, s[60:61] sc0 sc1
    s_add_u32 s40, s40, 1
    s_cmp_ge_u32 s40, 65536
    s_cbranch_scc1 L_give_o
    s_waitcnt vmcnt(0)
    v_cmp_ne_u32 vcc, 16, v14
    s_cbranch_vccnz L_poll_o
L_ok_o:
    s_mov_b64 exec, -1
    s_barrier
    buffer_load_dwordx4 v2, s[36:39], s12 offen sc1 lds
    s_add_u32 m0, m0, 4096
    s_add_u32 s12, s12, 4096
    buffer_load_dwordx4 v2, s[36:39], s12 offen sc1 lds
    s_add_u32 m0, m0, 4096
    s_add_u32 s12, s12, 4096
    buffer_load_dwordx4 v2, s[36:39], s12 offen sc1 lds
    s_add_u32 m0, m0, 4096
    s_add_u32 s12, s12, 4096
    buffer_load_dwordx4 v2, s[36:39], s12 offen sc1 lds
    s_add_u32 m0, m0, 4096
    s_add_u32 s12, s12, 4096
    buffer_load_dwordx4 v2, s[36:39], s12 offen sc1 lds
    s_add_u32 m0, m0, 4096
    s_add_u32 s12, s12, 4096
    buffer_load_dwordx4 v2, s[36:39], s12 offen sc1 lds
    s_add_u32 m0, m0, 4096
    s_add_u32 s12, s12, 4096
    buffer_load_dwordx4 v2, s[36:39], s12 offen sc1 lds
    s_add_u32 m0, m0, 4096
    s_add_u32 s12, s12, 4096
    buffer_load_dwordx4 v2, s[36:39], s12 offen sc1 lds
    s_waitcnt vmcnt(6)
    s_barrier
    s_cmp_ge_u32 s10, 14
    s_cbranch_scc1 L_idle3
    ds_read_b128 v[160:163], v2 offset:0
    ds_read_b128 v[164:167], v16 offset:1024
    ds_read_b128 v[168:171], v2 offset:3072
    ds_read_b128 v[172:175], v2 offset:4096
    ds_read_b128 v[176:179], v16 offset:5120
    s_waitcnt lgkmcnt(4)
    v_mfma_f32_32x32x16_bf16 v[224:239], v[32:35], v[160:163], 0
    ds_read_b128 v[180:183], v2 offset:7168
    s_waitcnt lgkmcnt(4)
    v_mfma_f32_32x32x16_bf16 v[224:239], v[36:39], v[164:167], v[224:239]
    ds_read_b64 v[184:185], v17 offset:1536
    ds_read_b64 v[186:187], v17 offset:2056
    s_waitcnt vmcnt(4)
    s_barrier
    ds_read_b128 v[188:191], v2 offset:8192
    s_waitcnt lgkmcnt(6)
    v_mfma_f32_32x32x16_bf16 v[224:239], v[40:43], v[168:171], v[224:239]
    ds_read_b128 v[160:163], v16 offset:9216
    s_waitcnt lgkmcnt(6)
    v_mfma_f32_32x32x16_bf16 v[224:239], v[44:47], v[172:175], v[224:239]
    ds_read_b128 v[164:167], v2 offset:11264
    s_waitcnt lgkmcnt(6)
    v_mfma_f32_32x32x16_bf16 v[224:239], v[48:51], v[176:179], v[224:239]
    ds_read_b128 v[168:171], v2 offset:12288
    s_waitcnt lgkmcnt(6)
    v_mfma_f32_32x32x16_bf16 v[224:239], v[52:55], v[180:183], v[224:239]
    ds_read_b128 v[172:175], v16 offset:13312
    s_waitcnt lgkmcnt(5)
    v_mfma_f32_32x32x16_bf16 v[224:239], v[56:59], v[184:187], v[224:239]
    ds_read_b128 v[176:179], v2 offset:15360
    s_waitcnt lgkmcnt(5)
    v_mfma_f32_32x32x16_bf16 v[224:239], v[60:63], v[188:191], v[224:239]
    ds_read_b64 v[180:181], v17 offset:9728
    ds_read_b64 v[182:183], v17 offset:10248
    s_waitcnt lgkmcnt(6)
    v_mfma_f32_32x32x16_bf16 v[224:239], v[64:67], v[160:163], v[224:239]
    s_waitcnt vmcnt(0)
    s_barrier
    ds_read_b128 v[184:187], v2 offset:16384
    s_waitcnt lgkmcnt(6)
    v_mfma_f32_32x32x16_bf16 v[224:239], v[68:71], v[164:167], v[224:239]
    ds_read_b128 v[188:191], v16 offset:17408
    s_waitcnt lgkmcnt(6)
    v_mfma_f32_32x32x16_bf16 v[224:239], v[72:75], v[168:171], v[224:239]
    ds_read_b128 v[160:163], v2 offset:19456
    s_waitcnt lgkmcnt(6)
    v_mfma_f32_32x32x16_bf16 v[224:239], v[76:79], v[172:175], v[224:239]
    ds_read_b128 v[164:167], v2 offset:20480
    s_waitcnt lgkmcnt(6)
    v_mfma_f32_32x32x16_bf16 v[224:239], v[80:83], v[176:179], v[224:239]
    ds_read_b128 v[168:171], v16 offset:21504
    s_waitcnt lgkmcnt(5)
    v_mfma_f32_32x32x16_bf16 v[224:239], v[84:87], v[180:183], v[224:239]
    ds_read_b128 v[172:175], v2 offset:23552
    s_waitcnt lgkmcnt(5)
    v_mfma_f32_32x32x16_bf16 v[224:239], v[88:91], v[184:187], v[224:239]
    ds_read_b64 v[176:177], v17 offset:17920
    ds_read_b64 v[178:179], v17 offset:18440
    s_waitcnt lgkmcnt(6)
    v_mfma_f32_32x32x16_bf16 v[224:239], v[92:95], v[188:191], v[224:239]
    ds_read_b128 v[180:183], v2 offset:24576
    s_waitcnt lgkmcnt(6)
    v_mfma_f32_32x32x16_bf16 v[224:239], v[96:99], v[160:163], v[224:239]
    ds_read_b128 v[184:187], v16 offset:25600
    s_waitcnt lgkmcnt(6)
    v_mfma_f32_32x32x16_bf16 v[224:239], v[100:103], v[164:167], v[224:239]
    ds_read_b128 v[188:191], v2 offset:27648
    s_waitcnt lgkmcnt(6)
    v_mfma_f32_32x32x16_bf16 v[224:239], v[104:107], v[168:171], v[224:239]
    ds_read_b128 v[160:163], v2 offset:28672
    s_waitcnt lgkmcnt(6)
    v_mfma_f32_32x32x16_bf16 v[224:239], v[108:111], v[172:175], v[224:239]
    ds_read_b128 v[164:167], v16 offset:29696
    s_waitcnt lgkmcnt(5)
    v_mfma_f32_32x32x16_bf16 v[224:239], v[112:115], v[176:179], v[224:239]
    ds_read_b128 v[168:171], v2 offset:31744
    s_waitcnt lgkmcnt(5)
    v_mfma_f32_32x32x16_bf16 v[224:239], v[116:119], v[180:183], v[224:239]
    ds_read_b64 v[172:173], v17 offset:26112
    ds_read_b64 v[174:175], v17 offset:26632
    s_waitcnt lgkmcnt(6)
    v_mfma_f32_32x32x16_bf16 v[224:239], v[120:123], v[184:187], v[224:239]
    s_waitcnt lgkmcnt(5)
    v_mfma_f32_32x32x16_bf16 v[224:239], v[124:127], v[188:191], v[224:239]
    s_waitcnt lgkmcnt(4)
    v_mfma_f32_32x32x16_bf16 v[224:239], v[128:131], v[160:163], v[224:239]
    s_waitcnt lgkmcnt(3)
    v_mfma_f32_32x32x16_bf16 v[224:239], v[132:135], v[164:167], v[224:239]
    s_waitcnt lgkmcnt(2)
    v_mfma_f32_32x32x16_bf16 v[224:239], v[136:139], v[168:171], v[224:239]
    s_waitcnt lgkmcnt(0)
    v_mfma_f32_32x32x16_bf16 v[224:239], v[140:143], v[172:175], v[224:239]
    s_nop 11
    v_pk_fma_f32 v[192:193], v[224:225], v[216:217], v[192:193] op_sel_hi:[1,0,1]
    v_pk_fma_f32 v[194:195], v[226:227], v[216:217], v[194:195] op_sel_hi:[1,0,1]
    v_pk_fma_f32 v[196:197], v[228:229], v[216:217], v[196:197] op_sel_hi:[1,0,1]
    v_pk_fma_f32 v[198:199], v[230:231], v[216:217], v[198:199] op_sel_hi:[1,0,1]
    v_cvt_pk_bf16_f32 v160, v192, v193
    v_cvt_pk_bf16_f32 v161, v194, v195
    v_cvt_pk_bf16_f32 v162, v196, v197
    v_cvt_pk_bf16_f32 v163, v198, v199
    ds_write_b128 v9, v[160:163]
    v_pk_fma_f32 v[200:201], v[232:233], v[216:217], v[200:201] op_sel_hi:[1,0,1]
    v_pk_fma_f32 v[202:203], v[234:235], v[216:217], v[202:203] op_sel_hi:[1,0,1]
    v_pk_fma_f32 v[204:205], v[236:237], v[216:217], v[204:205] op_sel_hi:[1,0,1]
    v_pk_fma_f32 v[206:207], v[238:239], v[216:217], v[206:207] op_sel_hi:[1,0,1]
    v_cvt_pk_bf16_f32 v164, v200, v201
    v_cvt_pk_bf16_f32 v165, v202, v203
    v_cvt_pk_bf16_f32 v166, v204, v205
    v_cvt_pk_bf16_f32 v167, v206, v207
    ds_write_b128 v3, v[164:167]
    ds_read_b128 v[168:171], v10
    ds_read_b128 v[172:175], v10 offset:1024
    s_waitcnt lgkmcnt(1)
    global_store_dwordx4 v12, v[168:171], s[96:97] sc1
    s_waitcnt lgkmcnt(0)
    global_store_dwordx4 v13, v[172:175], s[96:97] sc1
    s_endpgm
L_idle3:
    s_waitcnt vmcnt(0)
    s_endpgm
L_quit0:
    s_endpgm
L_qk:
    v_and_b32 v16, 1, v17
    v_lshrrev_b32 v17, 1, v17
    v_lshl_add_u32 v17, v16, 1, v17
    v_lshl_add_u32 v8, v17, 3, v8
    s_cmp_ge_u32 s53, 14
    s_cselect_b32 s47, 0x3e8b97f6, 1.0
    s_lshl_b32 s40, s52, 11
    v_add_u32 v6, s40, v231
    v_add_u32 v7, 1024, v6
    s_waitcnt vmcnt(10) lgkmcnt(0)
    s_barrier
    ds_read_b64_tr_b16 v[16:17], v8 offset:0
    ds_read_b64_tr_b16 v[18:19], v8 offset:1024
    ds_read_b128 v[176:179], v3 offset:0
    ds_read_b128 v[180:183], v3 offset:4096
    ds_read_b128 v[184:187], v3 offset:8192
    ds_read_b64_tr_b16 v[20:21], v8 offset:4096
    ds_read_b64_tr_b16 v[22:23], v8 offset:5120
    ds_read_b128 v[188:191], v4 offset:0
    ds_read_b128 v[192:195], v4 offset:4096
    ds_read_b128 v[196:199], v4 offset:8192
    ds_read_b64_tr_b16 v[24:25], v8 offset:8192
    ds_read_b64_tr_b16 v[26:27], v8 offset:9216
    ds_read_b128 v[200:203], v5 offset:0
    ds_read_b128 v[204:207], v5 offset:4096
    ds_read_b128 v[208:211], v5 offset:8192
    s_add_u32 s59, s57, 3
    s_sub_u32 s58, s59, 7
    s_min_u32 s59, s59, s58
    s_mul_i32 s58, s59, 172032
    s_lshl_b32 s59, s59, 7
    s_add_u32 m0, s45, 62848
    s_add_u32 s40, s58, 0
    buffer_load_dwordx4 v229, s[32:35], s40 offen lds
    s_add_u32 m0, s45, 79232
    s_add_u32 s41, s59, 0
    buffer_load_dwordx4 v252, s[28:31], s41 offen lds
    s_waitcnt lgkmcnt(10)
    v_mfma_f32_32x32x16_bf16 v[128:143], v[16:19], v[176:179], 0
    ds_read_b64_tr_b16 v[28:29], v8 offset:12288
    ds_read_b64_tr_b16 v[30:31], v8 offset:13312
    ds_read_b128 v[212:215], v15 offset:0
    s_add_u32 m0, s45, 66944
    s_add_u32 s40, s58, 43008
    buffer_load_dwordx4 v229, s[32:35], s40 offen lds
    v_mfma_f32_32x32x16_bf16 v[144:159], v[16:19], v[180:183], 0
    ds_read_b128 v[216:219], v15 offset:4096
    ds_read_b128 v[220:223], v15 offset:8192
    v_subrev_u32 v3, 20480, v3
    v_subrev_u32 v4, 20480, v4
    v_subrev_u32 v5, 20480, v5
    v_subrev_u32 v15, 20480, v15
    v_subrev_u32 v8, 20480, v8
    s_add_u32 m0, s45, 71040
    s_add_u32 s40, s58, 86016
    buffer_load_dwordx4 v229, s[32:35], s40 offen lds
    v_mfma_f32_32x32x16_bf16 v[160:175], v[16:19], v[184:187], 0
    s_add_u32 m0, s45, 75136
    s_add_u32 s40, s58, 129024
    buffer_load_dwordx4 v229, s[32:35], s40 offen lds
    s_waitcnt lgkmcnt(10)
    v_mfma_f32_32x32x16_bf16 v[128:143], v[20:23], v[188:191], v[128:143]
    s_add_u32 s59, s57, 4
    s_sub_u32 s58, s59, 7
    s_min_u32 s59, s59, s58
    s_mul_i32 s58, s59, 172032
    s_lshl_b32 s59, s59, 7
    s_add_u32 m0, s45, 42368
    s_add_u32 s40, s58, 0
    buffer_load_dwordx4 v229, s[32:35], s40 offen lds
    v_mfma_f32_32x32x16_bf16 v[144:159], v[20:23], v[192:195], v[144:159]
    s_add_u32 m0, s45, 58752
    s_add_u32 s41, s59, 0
    buffer_load_dwordx4 v252, s[28:31], s41 offen lds
    v_mfma_f32_32x32x16_bf16 v[160:175], v[20:23], v[196:199], v[160:175]
    s_add_u32 m0, s45, 46464
    s_add_u32 s40, s58, 43008
    buffer_load_dwordx4 v229, s[32:35], s40 offen lds
    s_waitcnt lgkmcnt(5)
    v_mfma_f32_32x32x16_bf16 v[128:143], v[24:27], v[200:203], v[128:143]
    s_add_u32 m0, s45, 50560
    s_add_u32 s40, s58, 86016
    buffer_load_dwordx4 v229, s[32:35], s40 offen lds
    v_mfma_f32_32x32x16_bf16 v[144:159], v[24:27], v[204:207], v[144:159]
    s_add_u32 m0, s45, 54656
    s_add_u32 s40, s58, 129024
    buffer_load_dwordx4 v229, s[32:35], s40 offen lds
    v_mfma_f32_32x32x16_bf16 v[160:175], v[24:27], v[208:211], v[160:175]
    s_waitcnt lgkmcnt(0)
    v_mfma_f32_32x32x16_bf16 v[128:143], v[28:31], v[212:215], v[128:143]
    v_mfma_f32_32x32x16_bf16 v[144:159], v[28:31], v[216:219], v[144:159]
    v_mfma_f32_32x32x16_bf16 v[160:175], v[28:31], v[220:223], v[160:175]
    s_waitcnt vmcnt(10)
    s_barrier
    ds_read_b64_tr_b16 v[32:33], v8 offset:49152
    ds_read_b64_tr_b16 v[34:35], v8 offset:50176
    ds_read_b128 v[176:179], v3 offset:49152
    ds_read_b64_tr_b16 v[36:37], v8 offset:53248
    ds_read_b64_tr_b16 v[38:39], v8 offset:54272
    ds_read_b128 v[180:183], v4 offset:49152
    ds_read_b64_tr_b16 v[40:41], v8 offset:57344
    ds_read_b64_tr_b16 v[42:43], v8 offset:58368
    ds_read_b128 v[184:187], v5 offset:49152
    ds_read_b64_tr_b16 v[44:45], v8 offset:61440
    ds_read_b64_tr_b16 v[46:47], v8 offset:62464
    ds_read_b128 v[188:191], v15 offset:49152
    ds_read_b64_tr_b16 v[48:49], v8 offset:0
    ds_read_b64_tr_b16 v[50:51], v8 offset:1024
    ds_read_b128 v[192:195], v3 offset:0
    s_add_u32 s59, s57, 5
    s_sub_u32 s58, s59, 7
    s_min_u32 s59, s59, s58
    s_mul_i32 s58, s59, 172032
    s_lshl_b32 s59, s59, 7
    s_add_u32 m0, s45, 21888
    s_add_u32 s40, s58, 0
    buffer_load_dwordx4 v229, s[32:35], s40 offen lds
    s_add_u32 m0, s45, 38272
    s_add_u32 s41, s59, 0
    buffer_load_dwordx4 v252, s[28:31], s41 offen lds
    s_waitcnt lgkmcnt(12)
    v_mfma_f32_32x32x16_bf16 v[128:143], v[32:35], v[176:179], v[128:143]
    ds_read_b64_tr_b16 v[52:53], v8 offset:4096
    ds_read_b64_tr_b16 v[54:55], v8 offset:5120
    ds_read_b128 v[196:199], v4 offset:0
    s_add_u32 m0, s45, 25984
    s_add_u32 s40, s58, 43008
    buffer_load_dwordx4 v229, s[32:35], s40 offen lds
    s_add_u32 m0, s45, 30080
    s_add_u32 s40, s58, 86016
    buffer_load_dwordx4 v229, s[32:35], s40 offen lds
    s_waitcnt lgkmcnt(12)
    v_mfma_f32_32x32x16_bf16 v[128:143], v[36:39], v[180:183], v[128:143]
    ds_read_b64_tr_b16 v[56:57], v8 offset:8192
    ds_read_b64_tr_b16 v[58:59], v8 offset:9216
    ds_read_b128 v[200:203], v5 offset:0
    s_add_u32 m0, s45, 34176
    s_add_u32 s40, s58, 129024
    buffer_load_dwordx4 v229, s[32:35], s40 offen lds
    s_add_u32 s59, s57, 6
    s_sub_u32 s58, s59, 7
    s_min_u32 s59, s59, s58
    s_mul_i32 s58, s59, 172032
    s_lshl_b32 s59, s59, 7
    s_add_u32 m0, s45, 1408
    s_add_u32 s40, s58, 0
    buffer_load_dwordx4 v229, s[32:35], s40 offen lds
    s_waitcnt lgkmcnt(12)
    v_mfma_f32_32x32x16_bf16 v[128:143], v[40:43], v[184:187], v[128:143]
    ds_read_b64_tr_b16 v[60:61], v8 offset:12288
    ds_read_b64_tr_b16 v[62:63], v8 offset:13312
    ds_read_b128 v[204:207], v15 offset:0
    v_subrev_u32 v3, 40960, v3
    v_subrev_u32 v4, 40960, v4
    v_subrev_u32 v5, 40960, v5
    v_subrev_u32 v15, 40960, v15
    v_subrev_u32 v8, 40960, v8
    s_add_u32 m0, s45, 17792
    s_add_u32 s41, s59, 0
    buffer_load_dwordx4 v252, s[28:31], s41 offen lds
    s_add_u32 m0, s45, 5504
    s_add_u32 s40, s58, 43008
    buffer_load_dwordx4 v229, s[32:35], s40 offen lds
    s_waitcnt lgkmcnt(12)
    v_mfma_f32_32x32x16_bf16 v[128:143], v[44:47], v[188:191], v[128:143]
    s_add_u32 m0, s45, 9600
    s_add_u32 s40, s58, 86016
    buffer_load_dwordx4 v229, s[32:35], s40 offen lds
    s_add_u32 m0, s45, 13696
    s_add_u32 s40, s58, 129024
    buffer_load_dwordx4 v229, s[32:35], s40 offen lds
    s_waitcnt lgkmcnt(9)
    v_mfma_f32_32x32x16_bf16 v[128:143], v[48:51], v[192:195], v[128:143]
    s_add_u32 s59, s57, 1
    s_sub_u32 s58, s59, 7
    s_min_u32 s59, s59, s58
    s_lshl_b32 s59, s59, 7
    s_add_u32 m0, s45, 107904
    s_add_u32 s41, s59, 28672
    buffer_load_dwordx4 v252, s[28:31], s41 offen lds
    s_add_u32 s59, s57, 2
    s_sub_u32 s58, s59, 7
    s_min_u32 s59, s59, s58
    s_lshl_b32 s59, s59, 7
    s_add_u32 m0, s45, 112000
    s_add_u32 s41, s59, 28672
    buffer_load_dwordx4 v252, s[28:31], s41 offen lds
    s_waitcnt lgkmcnt(6)
    v_mfma_f32_32x32x16_bf16 v[128:143], v[52:55], v[196:199], v[128:143]
    s_add_u32 s59, s57, 3
    s_sub_u32 s58, s59, 7
    s_min_u32 s59, s59, s58
    s_lshl_b32 s59, s59, 7
    s_add_u32 m0, s45, 116096
    s_add_u32 s41, s59, 28672
    buffer_load_dwordx4 v252, s[28:31], s41 offen lds
    s_add_u32 s59, s57, 4
    s_sub_u32 s58, s59, 7
    s_min_u32 s59, s59, s58
    s_lshl_b32 s59, s59, 7
    s_add_u32 m0, s45, 120192
    s_add_u32 s41, s59, 28672
    buffer_load_dwordx4 v252, s[28:31], s41 offen lds
    s_waitcnt lgkmcnt(3)
    v_mfma_f32_32x32x16_bf16 v[128:143], v[56:59], v[200:203], v[128:143]
    s_add_u32 s59, s57, 5
    s_sub_u32 s58, s59, 7
    s_min_u32 s59, s59, s58
    s_lshl_b32 s59, s59, 7
    s_add_u32 m0, s45, 124288
    s_add_u32 s41, s59, 28672
    buffer_load_dwordx4 v252, s[28:31], s41 offen lds
    s_add_u32 s59, s57, 6
    s_sub_u32 s58, s59, 7
    s_min_u32 s59, s59, s58
    s_lshl_b32 s59, s59, 7
    s_add_u32 m0, s45, 128384
    s_add_u32 s41, s59, 28672
    buffer_load_dwordx4 v252, s[28:31], s41 offen lds
    s_waitcnt lgkmcnt(0)
    v_mfma_f32_32x32x16_bf16 v[128:143], v[60:63], v[204:207], v[128:143]
    s_waitcnt vmcnt(16)
    s_barrier
    ds_read_b64_tr_b16 v[64:65], v8 offset:20480
    ds_read_b64_tr_b16 v[66:67], v8 offset:21504
    ds_read_b128 v[208:211], v3 offset:20480
    ds_read_b64_tr_b16 v[68:69], v8 offset:24576
    ds_read_b64_tr_b16 v[70:71], v8 offset:25600
    ds_read_b128 v[212:215], v4 offset:20480
    ds_read_b64_tr_b16 v[72:73], v8 offset:28672
    ds_read_b64_tr_b16 v[74:75], v8 offset:29696
    ds_read_b128 v[216:219], v5 offset:20480
    ds_read_b64_tr_b16 v[76:77], v8 offset:32768
    ds_read_b64_tr_b16 v[78:79], v8 offset:33792
    ds_read_b128 v[220:223], v15 offset:20480
    ds_read_b64_tr_b16 v[80:81], v8 offset:0
    ds_read_b64_tr_b16 v[82:83], v8 offset:1024
    ds_read_b128 v[176:179], v3 offset:0
    s_waitcnt lgkmcnt(12)
    v_mfma_f32_32x32x16_bf16 v[128:143], v[64:67], v[208:211], v[128:143]
    ds_read_b64_tr_b16 v[84:85], v8 offset:4096
    ds_read_b64_tr_b16 v[86:87], v8 offset:5120
    ds_read_b128 v[180:183], v4 offset:0
    s_waitcnt lgkmcnt(12)
    v_mfma_f32_32x32x16_bf16 v[128:143], v[68:71], v[212:215], v[128:143]
    ds_read_b64_tr_b16 v[88:89], v8 offset:8192
    ds_read_b64_tr_b16 v[90:91], v8 offset:9216
    ds_read_b128 v[184:187], v5 offset:0
    s_waitcnt lgkmcnt(12)
    v_mfma_f32_32x32x16_bf16 v[128:143], v[72:75], v[216:219], v[128:143]
    ds_read_b64_tr_b16 v[92:93], v8 offset:12288
    ds_read_b64_tr_b16 v[94:95], v8 offset:13312
    ds_read_b128 v[188:191], v15 offset:0
    v_subrev_u32 v3, 40960, v3
    v_subrev_u32 v4, 40960, v4
    v_subrev_u32 v5, 40960, v5
    v_subrev_u32 v15, 40960, v15
    v_subrev_u32 v8, 40960, v8
    s_waitcnt lgkmcnt(12)
    v_mfma_f32_32x32x16_bf16 v[128:143], v[76:79], v[220:223], v[128:143]
    s_waitcnt lgkmcnt(9)
    v_mfma_f32_32x32x16_bf16 v[128:143], v[80:83], v[176:179], v[128:143]
    s_waitcnt lgkmcnt(6)
    v_mfma_f32_32x32x16_bf16 v[128:143], v[84:87], v[180:183], v[128:143]
    s_waitcnt lgkmcnt(3)
    v_mfma_f32_32x32x16_bf16 v[128:143], v[88:91], v[184:187], v[128:143]
    s_waitcnt lgkmcnt(0)
    v_mfma_f32_32x32x16_bf16 v[128:143], v[92:95], v[188:191], v[128:143]
    s_waitcnt vmcnt(6)
    s_barrier
    ds_read_b64_tr_b16 v[96:97], v8 offset:20480
    ds_read_b64_tr_b16 v[98:99], v8 offset:21504
    ds_read_b128 v[192:195], v3 offset:20480
    ds_read_b64_tr_b16 v[100:101], v8 offset:24576
    ds_read_b64_tr_b16 v[102:103], v8 offset:25600
    ds_read_b128 v[196:199], v4 offset:20480
    ds_read_b64_tr_b16 v[104:105], v8 offset:28672
    ds_read_b64_tr_b16 v[106:107], v8 offset:29696
    ds_read_b128 v[200:203], v5 offset:20480
    ds_read_b64_tr_b16 v[108:109], v8 offset:32768
    ds_read_b64_tr_b16 v[110:111], v8 offset:33792
    ds_read_b128 v[204:207], v15 offset:20480
    ds_read_b64_tr_b16 v[112:113], v8 offset:0
    ds_read_b64_tr_b16 v[114:115], v8 offset:1024
    ds_read_b128 v[208:211], v3 offset:0
    s_waitcnt lgkmcnt(12)
    v_mfma_f32_32x32x16_bf16 v[128:143], v[96:99], v[192:195], v[128:143]
    ds_read_b64_tr_b16 v[116:117], v8 offset:4096
    ds_read_b64_tr_b16 v[118:119], v8 offset:5120
    ds_read_b128 v[212:215], v4 offset:0
    s_waitcnt lgkmcnt(12)
    v_mfma_f32_32x32x16_bf16 v[128:143], v[100:103], v[196:199], v[128:143]
    ds_read_b64_tr_b16 v[120:121], v8 offset:8192
    ds_read_b64_tr_b16 v[122:123], v8 offset:9216
    ds_read_b128 v[216:219], v5 offset:0
    s_waitcnt lgkmcnt(12)
    v_mfma_f32_32x32x16_bf16 v[128:143], v[104:107], v[200:203], v[128:143]
    ds_read_b64_tr_b16 v[124:125], v8 offset:12288
    ds_read_b64_tr_b16 v[126:127], v8 offset:13312
    ds_read_b128 v[220:223], v15 offset:0
    s_waitcnt lgkmcnt(12)
    v_mfma_f32_32x32x16_bf16 v[128:143], v[108:111], v[204:207], v[128:143]
    s_waitcnt lgkmcnt(9)
    s_waitcnt lgkmcnt(0)
    s_waitcnt vmcnt(0)
    s_barrier
    ds_read_b128 v[176:179], v10 offset:0
    ds_read_b128 v[180:183], v11 offset:0
    v_mfma_f32_32x32x16_bf16 v[128:143], v[112:115], v[208:211], v[128:143]
    ds_read_b128 v[184:187], v12 offset:0
    ds_read_b128 v[188:191], v13 offset:0
    v_mfma_f32_32x32x16_bf16 v[128:143], v[116:119], v[212:215], v[128:143]
    ds_read_b128 v[192:195], v10 offset:4096
    ds_read_b128 v[196:199], v11 offset:4096
    v_mfma_f32_32x32x16_bf16 v[128:143], v[120:123], v[216:219], v[128:143]
    ds_read_b128 v[200:203], v12 offset:4096
    ds_read_b128 v[204:207], v13 offset:4096
    v_mfma_f32_32x32x16_bf16 v[128:143], v[124:127], v[220:223], v[128:143]
    s_waitcnt lgkmcnt(7)
    v_mfma_f32_32x32x16_bf16 v[144:159], v[32:35], v[176:179], v[144:159]
    ds_read_b128 v[208:211], v10 offset:8192
    s_waitcnt lgkmcnt(7)
    v_mfma_f32_32x32x16_bf16 v[144:159], v[36:39], v[180:183], v[144:159]
    ds_read_b128 v[212:215], v11 offset:8192
    s_waitcnt lgkmcnt(7)
    v_mfma_f32_32x32x16_bf16 v[144:159], v[40:43], v[184:187], v[144:159]
    ds_read_b128 v[216:219], v12 offset:8192
    s_waitcnt lgkmcnt(7)
    v_mfma_f32_32x32x16_bf16 v[144:159], v[44:47], v[188:191], v[144:159]
    ds_read_b128 v[220:223], v13 offset:8192
    v_mul_f32 v128, s47, v128
    v_mul_f32 v129, s47, v129
    v_mul_f32 v130, s47, v130
    v_mul_f32 v131, s47, v131
    s_waitcnt lgkmcnt(7)
    v_mfma_f32_32x32x16_bf16 v[144:159], v[48:51], v[192:195], v[144:159]
    ds_read_b128 v[176:179], v10 offset:12288
    v_mul_f32 v132, s47, v132
    v_mul_f32 v133, s47, v133
    v_mul_f32 v134, s47, v134
    v_mul_f32 v135, s47, v135
    s_waitcnt lgkmcnt(7)
    v_mfma_f32_32x32x16_bf16 v[144:159], v[52:55], v[196:199], v[144:159]
    ds_read_b128 v[180:183], v11 offset:12288
    v_cvt_pk_bf16_f32 v240, v128, v129
    v_cvt_pk_bf16_f32 v241, v130, v131
    v_cvt_pk_bf16_f32 v242, v132, v133
    v_cvt_pk_bf16_f32 v243, v134, v135
    s_waitcnt lgkmcnt(7)
    v_mfma_f32_32x32x16_bf16 v[144:159], v[56:59], v[200:203], v[144:159]
    ds_read_b128 v[184:187], v12 offset:12288
    buffer_store_dwordx4 v[240:243], v6, s[4:7], s92 offen sc1
    v_mul_f32 v136, s47, v136
    v_mul_f32 v137, s47, v137
    v_mul_f32 v138, s47, v138
    s_waitcnt lgkmcnt(7)
    v_mfma_f32_32x32x16_bf16 v[144:159], v[60:63], v[204:207], v[144:159]
    ds_read_b128 v[188:191], v13 offset:12288
    v_mul_f32 v139, s47, v139
    v_mul_f32 v140, s47, v140
    v_mul_f32 v141, s47, v141
    v_mul_f32 v142, s47, v142
    s_waitcnt lgkmcnt(7)
    v_mfma_f32_32x32x16_bf16 v[144:159], v[64:67], v[208:211], v[144:159]
    ds_read_b128 v[192:195], v10 offset:16384
    v_mul_f32 v143, s47, v143
    v_cvt_pk_bf16_f32 v244, v136, v137
    v_cvt_pk_bf16_f32 v245, v138, v139
    v_cvt_pk_bf16_f32 v246, v140, v141
    s_waitcnt lgkmcnt(7)
    v_mfma_f32_32x32x16_bf16 v[144:159], v[68:71], v[212:215], v[144:159]
    ds_read_b128 v[196:199], v11 offset:16384
    v_cvt_pk_bf16_f32 v247, v142, v143
    buffer_store_dwordx4 v[244:247], v7, s[4:7], s92 offen sc1
    s_waitcnt lgkmcnt(7)
    v_mfma_f32_32x32x16_bf16 v[144:159], v[72:75], v[216:219], v[144:159]
    ds_read_b128 v[200:203], v12 offset:16384
    s_waitcnt lgkmcnt(7)
    v_mfma_f32_32x32x16_bf16 v[144:159], v[76:79], v[220:223], v[144:159]
    ds_read_b128 v[204:207], v13 offset:16384
    s_waitcnt lgkmcnt(7)
    v_mfma_f32_32x32x16_bf16 v[144:159], v[80:83], v[176:179], v[144:159]
    ds_read_b128 v[208:211], v10 offset:20480
    s_waitcnt lgkmcnt(7)
    v_mfma_f32_32x32x16_bf16 v[144:159], v[84:87], v[180:183], v[144:159]
    ds_read_b128 v[212:215], v11 offset:20480
    s_waitcnt lgkmcnt(7)
    v_mfma_f32_32x32x16_bf16 v[144:159], v[88:91], v[184:187], v[144:159]
    ds_read_b128 v[216:219], v12 offset:20480
    s_waitcnt lgkmcnt(7)
    v_mfma_f32_32x32x16_bf16 v[144:159], v[92:95], v[188:191], v[144:159]
    ds_read_b128 v[220:223], v13 offset:20480
    s_waitcnt lgkmcnt(7)
    v_mfma_f32_32x32x16_bf16 v[144:159], v[96:99], v[192:195], v[144:159]
    s_waitcnt lgkmcnt(6)
    v_mfma_f32_32x32x16_bf16 v[144:159], v[100:103], v[196:199], v[144:159]
    s_waitcnt lgkmcnt(0)
    s_barrier
    ds_read_b128 v[176:179], v10 offset:24576
    ds_read_b128 v[180:183], v11 offset:24576
    ds_read_b128 v[184:187], v12 offset:24576
    ds_read_b128 v[188:191], v13 offset:24576
    ds_read_b128 v[192:195], v10 offset:28672
    s_waitcnt lgkmcnt(10)
    v_mfma_f32_32x32x16_bf16 v[144:159], v[104:107], v[200:203], v[144:159]
    ds_read_b128 v[196:199], v11 offset:28672
    s_waitcnt lgkmcnt(10)
    v_mfma_f32_32x32x16_bf16 v[144:159], v[108:111], v[204:207], v[144:159]
    ds_read_b128 v[200:203], v12 offset:28672
    s_waitcnt lgkmcnt(10)
    v_mfma_f32_32x32x16_bf16 v[144:159], v[112:115], v[208:211], v[144:159]
    ds_read_b128 v[204:207], v13 offset:28672
    s_waitcnt lgkmcnt(10)
    v_mfma_f32_32x32x16_bf16 v[144:159], v[116:119], v[212:215], v[144:159]
    ds_read_b128 v[208:211], v10 offset:32768
    s_waitcnt lgkmcnt(10)
    v_mfma_f32_32x32x16_bf16 v[144:159], v[120:123], v[216:219], v[144:159]
    ds_read_b128 v[212:215], v11 offset:32768
    s_waitcnt lgkmcnt(10)
    v_mfma_f32_32x32x16_bf16 v[144:159], v[124:127], v[220:223], v[144:159]
    ds_read_b128 v[216:219], v12 offset:32768
    s_waitcnt lgkmcnt(10)
    v_mfma_f32_32x32x16_bf16 v[160:175], v[32:35], v[176:179], v[160:175]
    ds_read_b128 v[220:223], v13 offset:32768
    s_waitcnt lgkmcnt(10)
    v_mfma_f32_32x32x16_bf16 v[160:175], v[36:39], v[180:183], v[160:175]
    ds_read_b128 v[176:179], v10 offset:36864
    s_waitcnt lgkmcnt(10)
    v_mfma_f32_32x32x16_bf16 v[160:175], v[40:43], v[184:187], v[160:175]
    ds_read_b128 v[180:183], v11 offset:36864
    s_waitcnt lgkmcnt(10)
    v_mfma_f32_32x32x16_bf16 v[160:175], v[44:47], v[188:191], v[160:175]
    ds_read_b128 v[184:187], v12 offset:36864
    v_mul_f32 v144, s47, v144
    v_mul_f32 v145, s47, v145
    v_mul_f32 v146, s47, v146
    v_mul_f32 v147, s47, v147
    s_waitcnt lgkmcnt(10)
    v_mfma_f32_32x32x16_bf16 v[160:175], v[48:51], v[192:195], v[160:175]
    ds_read_b128 v[188:191], v13 offset:36864
    v_mul_f32 v148, s47, v148
    v_mul_f32 v149, s47, v149
    v_mul_f32 v150, s47, v150
    v_mul_f32 v151, s47, v151
    s_waitcnt lgkmcnt(10)
    v_mfma_f32_32x32x16_bf16 v[160:175], v[52:55], v[196:199], v[160:175]
    ds_read_b128 v[192:195], v10 offset:40960
    v_cvt_pk_bf16_f32 v240, v144, v145
    v_cvt_pk_bf16_f32 v241, v146, v147
    v_cvt_pk_bf16_f32 v242, v148, v149
    v_cvt_pk_bf16_f32 v243, v150, v151
    s_waitcnt lgkmcnt(10)
    v_mfma_f32_32x32x16_bf16 v[160:175], v[56:59], v[200:203], v[160:175]
    ds_read_b128 v[196:199], v11 offset:40960
    buffer_store_dwordx4 v[240:243], v6, s[4:7], s93 offen sc1
    v_mul_f32 v152, s47, v152
    v_mul_f32 v153, s47, v153
    v_mul_f32 v154, s47, v154
    s_waitcnt lgkmcnt(10)
    v_mfma_f32_32x32x16_bf16 v[160:175], v[60:63], v[204:207], v[160:175]
    ds_read_b128 v[200:203], v12 offset:40960
    v_mul_f32 v155, s47, v155
    v_mul_f32 v156, s47, v156
    v_mul_f32 v157, s47, v157
    v_mul_f32 v158, s47, v158
    s_waitcnt lgkmcnt(10)
    v_mfma_f32_32x32x16_bf16 v[160:175], v[64:67], v[208:211], v[160:175]
    ds_read_b128 v[204:207], v13 offset:40960
    v_mul_f32 v159, s47, v159
    v_cvt_pk_bf16_f32 v244, v152, v153
    v_cvt_pk_bf16_f32 v245, v154, v155
    v_cvt_pk_bf16_f32 v246, v156, v157
    s_waitcnt lgkmcnt(10)
    v_mfma_f32_32x32x16_bf16 v[160:175], v[68:71], v[212:215], v[160:175]
    ds_read_b128 v[208:211], v10 offset:45056
    v_cvt_pk_bf16_f32 v247, v158, v159
    buffer_store_dwordx4 v[244:247], v7, s[4:7], s93 offen sc1
    s_waitcnt lgkmcnt(10)
    v_mfma_f32_32x32x16_bf16 v[160:175], v[72:75], v[216:219], v[160:175]
    ds_read_b128 v[212:215], v11 offset:45056
    s_waitcnt lgkmcnt(10)
    v_mfma_f32_32x32x16_bf16 v[160:175], v[76:79], v[220:223], v[160:175]
    ds_read_b128 v[216:219], v12 offset:45056
    s_waitcnt lgkmcnt(10)
    v_mfma_f32_32x32x16_bf16 v[160:175], v[80:83], v[176:179], v[160:175]
    ds_read_b128 v[220:223], v13 offset:45056
    s_waitcnt lgkmcnt(10)
    v_mfma_f32_32x32x16_bf16 v[160:175], v[84:87], v[180:183], v[160:175]
    s_waitcnt lgkmcnt(9)
    v_mfma_f32_32x32x16_bf16 v[160:175], v[88:91], v[184:187], v[160:175]
    s_waitcnt lgkmcnt(8)
    v_mfma_f32_32x32x16_bf16 v[160:175], v[92:95], v[188:191], v[160:175]
    s_waitcnt lgkmcnt(7)
    v_mfma_f32_32x32x16_bf16 v[160:175], v[96:99], v[192:195], v[160:175]
    s_waitcnt lgkmcnt(6)
    v_mfma_f32_32x32x16_bf16 v[160:175], v[100:103], v[196:199], v[160:175]
    s_waitcnt lgkmcnt(5)
    v_mfma_f32_32x32x16_bf16 v[160:175], v[104:107], v[200:203], v[160:175]
    s_waitcnt lgkmcnt(4)
    v_mfma_f32_32x32x16_bf16 v[160:175], v[108:111], v[204:207], v[160:175]
    s_waitcnt lgkmcnt(3)
    v_mfma_f32_32x32x16_bf16 v[160:175], v[112:115], v[208:211], v[160:175]
    s_waitcnt lgkmcnt(2)
    v_mfma_f32_32x32x16_bf16 v[160:175], v[116:119], v[212:215], v[160:175]
    s_waitcnt lgkmcnt(1)
    v_mfma_f32_32x32x16_bf16 v[160:175], v[120:123], v[216:219], v[160:175]
    s_waitcnt lgkmcnt(0)
    v_mfma_f32_32x32x16_bf16 v[160:175], v[124:127], v[220:223], v[160:175]
    s_cmp_ge_u32 s53, 14
    s_nop 9
    s_cbranch_scc1 L_kscale
L_kscaled:
    v_cvt_pk_bf16_f32 v240, v160, v161
    v_cvt_pk_bf16_f32 v241, v162, v163
    v_cvt_pk_bf16_f32 v242, v164, v165
    v_cvt_pk_bf16_f32 v243, v166, v167
    buffer_store_dwordx4 v[240:243], v6, s[4:7], s94 offen sc1
    v_cvt_pk_bf16_f32 v244, v168, v169
    v_cvt_pk_bf16_f32 v245, v170, v171
    v_cvt_pk_bf16_f32 v246, v172, v173
    v_cvt_pk_bf16_f32 v247, v174, v175
    buffer_store_dwordx4 v[244:247], v7, s[4:7], s94 offen sc1
    s_branch L_signal
L_gate:
    v_lshlrev_b32 v9, 4, v2
    v_add_u32 v9, 157056, v9
    s_lshl_b32 s47, s46, 7
    v_add_u32 v8, s47, v9
    s_add_u32 s4, s22, 10485760
    s_addc_u32 s5, s23, 0
    s_cmp_eq_u32 s53, 42
    s_cselect_b32 s6, 8192, 0
    s_mul_i32 s40, s25, 384
    v_lshl_add_u32 v6, v1, 2, s40
    v_mov_b32 v7, v6
    s_waitcnt vmcnt(10) lgkmcnt(0)
    s_barrier
    ds_read_b128 v[16:19], v8 offset:0
    ds_read_b128 v[176:179], v3 offset:0
    ds_read_b128 v[180:183], v3 offset:4096
    ds_read_b128 v[184:187], v3 offset:8192
    ds_read_b128 v[20:23], v8 offset:32
    ds_read_b128 v[188:191], v4 offset:0
    ds_read_b128 v[192:195], v4 offset:4096
    ds_read_b128 v[196:199], v4 offset:8192
    ds_read_b128 v[24:27], v8 offset:64
    ds_read_b128 v[200:203], v5 offset:0
    ds_read_b128 v[204:207], v5 offset:4096
    ds_read_b128 v[208:211], v5 offset:8192
    ds_read_b128 v[28:31], v8 offset:96
    ds_read_b128 v[212:215], v15 offset:0
    ds_read_b128 v[216:219], v15 offset:4096
    s_add_u32 s59, s57, 3
    s_sub_u32 s58, s59, 7
    s_min_u32 s59, s59, s58
    s_mul_i32 s58, s59, 172032
    s_lshl_b32 s59, s59, 7
    s_add_u32 m0, s45, 62848
    s_add_u32 s40, s58, 0
    buffer_load_dwordx4 v229, s[32:35], s40 offen lds
    s_add_u32 m0, s45, 79232
    s_add_u32 s41, s59, 0
    buffer_load_dwordx4 v252, s[28:31], s41 offen lds
    s_waitcnt lgkmcnt(11)
    v_mfma_f32_32x32x16_bf16 v[128:143], v[16:19], v[176:179], 0
    ds_read_b128 v[220:223], v15 offset:8192
    s_add_u32 s46, s46, 1
    s_cmp_eq_u32 s46, 7
    s_cselect_b32 s46, 0, s46
    s_lshl_b32 s47, s46, 7
    v_add_u32 v8, s47, v9
    v_subrev_u32 v3, 20480, v3
    v_subrev_u32 v4, 20480, v4
    v_subrev_u32 v5, 20480, v5
    v_subrev_u32 v15, 20480, v15
    s_add_u32 m0, s45, 66944
    s_add_u32 s40, s58, 43008
    buffer_load_dwordx4 v229, s[32:35], s40 offen lds
    v_mfma_f32_32x32x16_bf16 v[144:159], v[16:19], v[180:183], 0
    s_add_u32 m0, s45, 71040
    s_add_u32 s40, s58, 86016
    buffer_load_dwordx4 v229, s[32:35], s40 offen lds
    v_mfma_f32_32x32x16_bf16 v[160:175], v[16:19], v[184:187], 0
    s_add_u32 m0, s45, 75136
    s_add_u32 s40, s58, 129024
    buffer_load_dwordx4 v229, s[32:35], s40 offen lds
    s_waitcnt lgkmcnt(8)
    v_mfma_f32_32x32x16_bf16 v[128:143], v[20:23], v[188:191], v[128:143]
    s_add_u32 s59, s57, 4
    s_sub_u32 s58, s59, 7
    s_min_u32 s59, s59, s58
    s_mul_i32 s58, s59, 172032
    s_lshl_b32 s59, s59, 7
    s_add_u32 m0, s45, 42368
    s_add_u32 s40, s58, 0
    buffer_load_dwordx4 v229, s[32:35], s40 offen lds
    v_mfma_f32_32x32x16_bf16 v[144:159], v[20:23], v[192:195], v[144:159]
    s_add_u32 m0, s45, 58752
    s_add_u32 s41, s59, 0
    buffer_load_dwordx4 v252, s[28:31], s41 offen lds
    v_mfma_f32_32x32x16_bf16 v[160:175], v[20:23], v[196:199], v[160:175]
    s_add_u32 m0, s45, 46464
    s_add_u32 s40, s58, 43008
    buffer_load_dwordx4 v229, s[32:35], s40 offen lds
    s_waitcnt lgkmcnt(4)
    v_mfma_f32_32x32x16_bf16 v[128:143], v[24:27], v[200:203], v[128:143]
    s_add_u32 m0, s45, 50560
    s_add_u32 s40, s58, 86016
    buffer_load_dwordx4 v229, s[32:35], s40 offen lds
    v_mfma_f32_32x32x16_bf16 v[144:159], v[24:27], v[204:207], v[144:159]
    s_add_u32 m0, s45, 54656
    s_add_u32 s40, s58, 129024
    buffer_load_dwordx4 v229, s[32:35], s40 offen lds
    v_mfma_f32_32x32x16_bf16 v[160:175], v[24:27], v[208:211], v[160:175]
    s_waitcnt lgkmcnt(0)
    v_mfma_f32_32x32x16_bf16 v[128:143], v[28:31], v[212:215], v[128:143]
    v_mfma_f32_32x32x16_bf16 v[144:159], v[28:31], v[216:219], v[144:159]
    v_mfma_f32_32x32x16_bf16 v[160:175], v[28:31], v[220:223], v[160:175]
    s_waitcnt vmcnt(10)
    s_barrier
    ds_read_b128 v[32:35], v8 offset:0
    ds_read_b128 v[176:179], v3 offset:49152
    ds_read_b128 v[36:39], v8 offset:32
    ds_read_b128 v[180:183], v4 offset:49152
    ds_read_b128 v[40:43], v8 offset:64
    ds_read_b128 v[184:187], v5 offset:49152
    ds_read_b128 v[44:47], v8 offset:96
    ds_read_b128 v[188:191], v15 offset:49152
    s_add_u32 s46, s46, 1
    s_cmp_eq_u32 s46, 7
    s_cselect_b32 s46, 0, s46
    s_lshl_b32 s47, s46, 7
    v_add_u32 v8, s47, v9
    ds_read_b128 v[48:51], v8 offset:0
    ds_read_b128 v[192:195], v3 offset:0
    ds_read_b128 v[52:55], v8 offset:32
    ds_read_b128 v[196:199], v4 offset:0
    ds_read_b128 v[56:59], v8 offset:64
    ds_read_b128 v[200:203], v5 offset:0
    ds_read_b128 v[60:63], v8 offset:96
    s_add_u32 s59, s57, 5
    s_sub_u32 s58, s59, 7
    s_min_u32 s59, s59, s58
    s_mul_i32 s58, s59, 172032
    s_lshl_b32 s59, s59, 7
    s_add_u32 m0, s45, 21888
    s_add_u32 s40, s58, 0
    buffer_load_dwordx4 v229, s[32:35], s40 offen lds
    s_add_u32 m0, s45, 38272
    s_add_u32 s41, s59, 0
    buffer_load_dwordx4 v252, s[28:31], s41 offen lds
    s_waitcnt lgkmcnt(13)
    v_mfma_f32_32x32x16_bf16 v[128:143], v[32:35], v[176:179], v[128:143]
    ds_read_b128 v[204:207], v15 offset:0
    s_add_u32 s46, s46, 1
    s_cmp_eq_u32 s46, 7
    s_cselect_b32 s46, 0, s46
    s_lshl_b32 s47, s46, 7
    v_add_u32 v8, s47, v9
    v_subrev_u32 v3, 40960, v3
    v_subrev_u32 v4, 40960, v4
    v_subrev_u32 v5, 40960, v5
    v_subrev_u32 v15, 40960, v15
    s_add_u32 m0, s45, 25984
    s_add_u32 s40, s58, 43008
    buffer_load_dwordx4 v229, s[32:35], s40 offen lds
    s_add_u32 m0, s45, 30080
    s_add_u32 s40, s58, 86016
    buffer_load_dwordx4 v229, s[32:35], s40 offen lds
    s_waitcnt lgkmcnt(12)
    v_mfma_f32_32x32x16_bf16 v[128:143], v[36:39], v[180:183], v[128:143]
    s_add_u32 m0, s45, 34176
    s_add_u32 s40, s58, 129024
    buffer_load_dwordx4 v229, s[32:35], s40 offen lds
    s_add_u32 s59, s57, 6
    s_sub_u32 s58, s59, 7
    s_min_u32 s59, s59, s58
    s_mul_i32 s58, s59, 172032
    s_lshl_b32 s59, s59, 7
    s_add_u32 m0, s45, 1408
    s_add_u32 s40, s58, 0
    buffer_load_dwordx4 v229, s[32:35], s40 offen lds
    s_waitcnt lgkmcnt(10)
    v_mfma_f32_32x32x16_bf16 v[128:143], v[40:43], v[184:187], v[128:143]
    s_add_u32 m0, s45, 17792
    s_add_u32 s41, s59, 0
    buffer_load_dwordx4 v252, s[28:31], s41 offen lds
    s_add_u32 m0, s45, 5504
    s_add_u32 s40, s58, 43008
    buffer_load_dwordx4 v229, s[32:35], s40 offen lds
    s_waitcnt lgkmcnt(8)
    v_mfma_f32_32x32x16_bf16 v[128:143], v[44:47], v[188:191], v[128:143]
    s_add_u32 m0, s45, 9600
    s_add_u32 s40, s58, 86016
    buffer_load_dwordx4 v229, s[32:35], s40 offen lds
    s_add_u32 m0, s45, 13696
    s_add_u32 s40, s58, 129024
    buffer_load_dwordx4 v229, s[32:35], s40 offen lds
    s_waitcnt lgkmcnt(6)
    v_mfma_f32_32x32x16_bf16 v[128:143], v[48:51], v[192:195], v[128:143]
    s_add_u32 s59, s57, 1
    s_sub_u32 s58, s59, 7
    s_min_u32 s59, s59, s58
    s_lshl_b32 s59, s59, 7
    s_add_u32 m0, s45, 107904
    s_add_u32 s41, s59, 28672
    buffer_load_dwordx4 v252, s[28:31], s41 offen lds
    s_add_u32 s59, s57, 2
    s_sub_u32 s58, s59, 7
    s_min_u32 s59, s59, s58
    s_lshl_b32 s59, s59, 7
    s_add_u32 m0, s45, 112000
    s_add_u32 s41, s59, 28672
    buffer_load_dwordx4 v252, s[28:31], s41 offen lds
    s_waitcnt lgkmcnt(4)
    v_mfma_f32_32x32x16_bf16 v[128:143], v[52:55], v[196:199], v[128:143]
    s_add_u32 s59, s57, 3
    s_sub_u32 s58, s59, 7
    s_min_u32 s59, s59, s58
    s_lshl_b32 s59, s59, 7
    s_add_u32 m0, s45, 116096
    s_add_u32 s41, s59, 28672
    buffer_load_dwordx4 v252, s[28:31], s41 offen lds
    s_add_u32 s59, s57, 4
    s_sub_u32 s58, s59, 7
    s_min_u32 s59, s59, s58
    s_lshl_b32 s59, s59, 7
    s_add_u32 m0, s45, 120192
    s_add_u32 s41, s59, 28672
    buffer_load_dwordx4 v252, s[28:31], s41 offen lds
    s_waitcnt lgkmcnt(2)
    v_mfma_f32_32x32x16_bf16 v[128:143], v[56:59], v[200:203], v[128:143]
    s_add_u32 s59, s57, 5
    s_sub_u32 s58, s59, 7
    s_min_u32 s59, s59, s58
    s_lshl_b32 s59, s59, 7
    s_add_u32 m0, s45, 124288
    s_add_u32 s41, s59, 28672
    buffer_load_dwordx4 v252, s[28:31], s41 offen lds
    s_add_u32 s59, s57, 6
    s_sub_u32 s58, s59, 7
    s_min_u32 s59, s59, s58
    s_lshl_b32 s59, s59, 7
    s_add_u32 m0, s45, 128384
    s_add_u32 s41, s59, 28672
    buffer_load_dwordx4 v252, s[28:31], s41 offen lds
    s_waitcnt lgkmcnt(0)
    v_mfma_f32_32x32x16_bf16 v[128:143], v[60:63], v[204:207], v[128:143]
    s_waitcnt vmcnt(16)
    s_barrier
    ds_read_b128 v[64:67], v8 offset:0
    ds_read_b128 v[208:211], v3 offset:20480
    ds_read_b128 v[68:71], v8 offset:32
    ds_read_b128 v[212:215], v4 offset:20480
    ds_read_b128 v[72:75], v8 offset:64
    ds_read_b128 v[216:219], v5 offset:20480
    ds_read_b128 v[76:79], v8 offset:96
    ds_read_b128 v[220:223], v15 offset:20480
    s_add_u32 s46, s46, 1
    s_cmp_eq_u32 s46, 7
    s_cselect_b32 s46, 0, s46
    s_lshl_b32 s47, s46, 7
    v_add_u32 v8, s47, v9
    ds_read_b128 v[80:83], v8 offset:0
    ds_read_b128 v[176:179], v3 offset:0
    ds_read_b128 v[84:87], v8 offset:32
    ds_read_b128 v[180:183], v4 offset:0
    ds_read_b128 v[88:91], v8 offset:64
    ds_read_b128 v[184:187], v5 offset:0
    ds_read_b128 v[92:95], v8 offset:96
    s_waitcnt lgkmcnt(13)
    v_mfma_f32_32x32x16_bf16 v[128:143], v[64:67], v[208:211], v[128:143]
    ds_read_b128 v[188:191], v15 offset:0
    s_add_u32 s46, s46, 1
    s_cmp_eq_u32 s46, 7
    s_cselect_b32 s46, 0, s46
    s_lshl_b32 s47, s46, 7
    v_add_u32 v8, s47, v9
    v_subrev_u32 v3, 40960, v3
    v_subrev_u32 v4, 40960, v4
    v_subrev_u32 v5, 40960, v5
    v_subrev_u32 v15, 40960, v15
    s_waitcnt lgkmcnt(12)
    v_mfma_f32_32x32x16_bf16 v[128:143], v[68:71], v[212:215], v[128:143]
    s_waitcnt lgkmcnt(10)
    v_mfma_f32_32x32x16_bf16 v[128:143], v[72:75], v[216:219], v[128:143]
    s_waitcnt lgkmcnt(8)
    v_mfma_f32_32x32x16_bf16 v[128:143], v[76:79], v[220:223], v[128:143]
    s_waitcnt lgkmcnt(6)
    v_mfma_f32_32x32x16_bf16 v[128:143], v[80:83], v[176:179], v[128:143]
    s_waitcnt lgkmcnt(4)
    v_mfma_f32_32x32x16_bf16 v[128:143], v[84:87], v[180:183], v[128:143]
    s_waitcnt lgkmcnt(2)
    v_mfma_f32_32x32x16_bf16 v[128:143], v[88:91], v[184:187], v[128:143]
    s_waitcnt lgkmcnt(0)
    v_mfma_f32_32x32x16_bf16 v[128:143], v[92:95], v[188:191], v[128:143]
    s_waitcnt vmcnt(6)
    s_barrier
    ds_read_b128 v[96:99], v8 offset:0
    ds_read_b128 v[192:195], v3 offset:20480
    ds_read_b128 v[100:103], v8 offset:32
    ds_read_b128 v[196:199], v4 offset:20480
    ds_read_b128 v[104:107], v8 offset:64
    ds_read_b128 v[200:203], v5 offset:20480
    ds_read_b128 v[108:111], v8 offset:96
    ds_read_b128 v[204:207], v15 offset:20480
    s_add_u32 s46, s46, 1
    s_cmp_eq_u32 s46, 7
    s_cselect_b32 s46, 0, s46
    s_lshl_b32 s47, s46, 7
    v_add_u32 v8, s47, v9
    ds_read_b128 v[112:115], v8 offset:0
    ds_read_b128 v[208:211], v3 offset:0
    ds_read_b128 v[116:119], v8 offset:32
    ds_read_b128 v[212:215], v4 offset:0
    ds_read_b128 v[120:123], v8 offset:64
    ds_read_b128 v[216:219], v5 offset:0
    ds_read_b128 v[124:127], v8 offset:96
    s_waitcnt lgkmcnt(13)
    v_mfma_f32_32x32x16_bf16 v[128:143], v[96:99], v[192:195], v[128:143]
    ds_read_b128 v[220:223], v15 offset:0
    s_waitcnt lgkmcnt(12)
    v_mfma_f32_32x32x16_bf16 v[128:143], v[100:103], v[196:199], v[128:143]
    s_waitcnt lgkmcnt(10)
    v_mfma_f32_32x32x16_bf16 v[128:143], v[104:107], v[200:203], v[128:143]
    s_waitcnt lgkmcnt(8)
    v_mfma_f32_32x32x16_bf16 v[128:143], v[108:111], v[204:207], v[128:143]
    s_waitcnt lgkmcnt(6)
    s_waitcnt lgkmcnt(0)
    s_waitcnt vmcnt(0)
    s_barrier
    ds_read_b128 v[176:179], v10 offset:0
    ds_read_b128 v[180:183], v11 offset:0
    v_mfma_f32_32x32x16_bf16 v[128:143], v[112:115], v[208:211], v[128:143]
    ds_read_b128 v[184:187], v12 offset:0
    ds_read_b128 v[188:191], v13 offset:0
    v_mfma_f32_32x32x16_bf16 v[128:143], v[116:119], v[212:215], v[128:143]
    ds_read_b128 v[192:195], v10 offset:4096
    ds_read_b128 v[196:199], v11 offset:4096
    v_mfma_f32_32x32x16_bf16 v[128:143], v[120:123], v[216:219], v[128:143]
    ds_read_b128 v[200:203], v12 offset:4096
    ds_read_b128 v[204:207], v13 offset:4096
    v_mfma_f32_32x32x16_bf16 v[128:143], v[124:127], v[220:223], v[128:143]
    s_waitcnt lgkmcnt(7)
    v_mfma_f32_32x32x16_bf16 v[144:159], v[32:35], v[176:179], v[144:159]
    ds_read_b128 v[208:211], v10 offset:8192
    s_waitcnt lgkmcnt(7)
    v_mfma_f32_32x32x16_bf16 v[144:159], v[36:39], v[180:183], v[144:159]
    ds_read_b128 v[212:215], v11 offset:8192
    s_waitcnt lgkmcnt(7)
    v_mfma_f32_32x32x16_bf16 v[144:159], v[40:43], v[184:187], v[144:159]
    ds_read_b128 v[216:219], v12 offset:8192
    s_waitcnt lgkmcnt(7)
    v_mfma_f32_32x32x16_bf16 v[144:159], v[44:47], v[188:191], v[144:159]
    ds_read_b128 v[220:223], v13 offset:8192
    v_cvt_pk_bf16_f32 v128, v128, v128
    v_and_b32 v128, 0xffff0000, v128
    v_mul_f32 v128, 0xbfb8aa3b, v128
    v_exp_f32 v128, v128
    s_waitcnt lgkmcnt(7)
    v_mfma_f32_32x32x16_bf16 v[144:159], v[48:51], v[192:195], v[144:159]
    ds_read_b128 v[176:179], v10 offset:12288
    s_nop 0
    v_add_f32 v128, 1.0, v128
    v_rcp_f32 v128, v128
    s_nop 0
    s_waitcnt lgkmcnt(7)
    v_mfma_f32_32x32x16_bf16 v[144:159], v[52:55], v[196:199], v[144:159]
    ds_read_b128 v[180:183], v11 offset:12288
    v_cvt_pk_bf16_f32 v128, v128, v128
    v_and_b32 v128, 0xffff0000, v128
    buffer_store_dword v128, v6, s[4:7], 0 offen offset:0 sc1
    s_waitcnt lgkmcnt(7)
    v_mfma_f32_32x32x16_bf16 v[144:159], v[56:59], v[200:203], v[144:159]
    ds_read_b128 v[184:187], v12 offset:12288
    s_waitcnt lgkmcnt(7)
    v_mfma_f32_32x32x16_bf16 v[144:159], v[60:63], v[204:207], v[144:159]
    ds_read_b128 v[188:191], v13 offset:12288
    s_waitcnt lgkmcnt(7)
    v_mfma_f32_32x32x16_bf16 v[144:159], v[64:67], v[208:211], v[144:159]
    ds_read_b128 v[192:195], v10 offset:16384
    s_waitcnt lgkmcnt(7)
    v_mfma_f32_32x32x16_bf16 v[144:159], v[68:71], v[212:215], v[144:159]
    ds_read_b128 v[196:199], v11 offset:16384
    s_waitcnt lgkmcnt(7)
    v_mfma_f32_32x32x16_bf16 v[144:159], v[72:75], v[216:219], v[144:159]
    ds_read_b128 v[200:203], v12 offset:16384
    s_waitcnt lgkmcnt(7)
    v_mfma_f32_32x32x16_bf16 v[144:159], v[76:79], v[220:223], v[144:159]
    ds_read_b128 v[204:207], v13 offset:16384
    s_waitcnt lgkmcnt(7)
    v_mfma_f32_32x32x16_bf16 v[144:159], v[80:83], v[176:179], v[144:159]
    ds_read_b128 v[208:211], v10 offset:20480
    s_waitcnt lgkmcnt(7)
    v_mfma_f32_32x32x16_bf16 v[144:159], v[84:87], v[180:183], v[144:159]
    ds_read_b128 v[212:215], v11 offset:20480
    s_waitcnt lgkmcnt(7)
    v_mfma_f32_32x32x16_bf16 v[144:159], v[88:91], v[184:187], v[144:159]
    ds_read_b128 v[216:219], v12 offset:20480
    s_waitcnt lgkmcnt(7)
    v_mfma_f32_32x32x16_bf16 v[144:159], v[92:95], v[188:191], v[144:159]
    ds_read_b128 v[220:223], v13 offset:20480
    s_waitcnt lgkmcnt(7)
    v_mfma_f32_32x32x16_bf16 v[144:159], v[96:99], v[192:195], v[144:159]
    s_waitcnt lgkmcnt(6)
    v_mfma_f32_32x32x16_bf16 v[144:159], v[100:103], v[196:199], v[144:159]
    s_waitcnt lgkmcnt(0)
    s_barrier
    ds_read_b128 v[176:179], v10 offset:24576
    ds_read_b128 v[180:183], v11 offset:24576
    ds_read_b128 v[184:187], v12 offset:24576
    ds_read_b128 v[188:191], v13 offset:24576
    ds_read_b128 v[192:195], v10 offset:28672
    s_waitcnt lgkmcnt(10)
    v_mfma_f32_32x32x16_bf16 v[144:159], v[104:107], v[200:203], v[144:159]
    ds_read_b128 v[196:199], v11 offset:28672
    s_waitcnt lgkmcnt(10)
    v_mfma_f32_32x32x16_bf16 v[144:159], v[108:111], v[204:207], v[144:159]
    ds_read_b128 v[200:203], v12 offset:28672
    s_waitcnt lgkmcnt(10)
    v_mfma_f32_32x32x16_bf16 v[144:159], v[112:115], v[208:211], v[144:159]
    ds_read_b128 v[204:207], v13 offset:28672
    s_waitcnt lgkmcnt(10)
    v_mfma_f32_32x32x16_bf16 v[144:159], v[116:119], v[212:215], v[144:159]
    ds_read_b128 v[208:211], v10 offset:32768
    s_waitcnt lgkmcnt(10)
    v_mfma_f32_32x32x16_bf16 v[144:159], v[120:123], v[216:219], v[144:159]
    ds_read_b128 v[212:215], v11 offset:32768
    s_waitcnt lgkmcnt(10)
    v_mfma_f32_32x32x16_bf16 v[144:159], v[124:127], v[220:223], v[144:159]
    ds_read_b128 v[216:219], v12 offset:32768
    s_waitcnt lgkmcnt(10)
    v_mfma_f32_32x32x16_bf16 v[160:175], v[32:35], v[176:179], v[160:175]
    ds_read_b128 v[220:223], v13 offset:32768
    s_waitcnt lgkmcnt(10)
    v_mfma_f32_32x32x16_bf16 v[160:175], v[36:39], v[180:183], v[160:175]
    ds_read_b128 v[176:179], v10 offset:36864
    s_waitcnt lgkmcnt(10)
    v_mfma_f32_32x32x16_bf16 v[160:175], v[40:43], v[184:187], v[160:175]
    ds_read_b128 v[180:183], v11 offset:36864
    s_waitcnt lgkmcnt(10)
    v_mfma_f32_32x32x16_bf16 v[160:175], v[44:47], v[188:191], v[160:175]
    ds_read_b128 v[184:187], v12 offset:36864
    v_cvt_pk_bf16_f32 v144, v144, v144
    v_and_b32 v144, 0xffff0000, v144
    v_mul_f32 v144, 0xbfb8aa3b, v144
    v_exp_f32 v144, v144
    s_waitcnt lgkmcnt(10)
    v_mfma_f32_32x32x16_bf16 v[160:175], v[48:51], v[192:195], v[160:175]
    ds_read_b128 v[188:191], v13 offset:36864
    s_nop 0
    v_add_f32 v144, 1.0, v144
    v_rcp_f32 v144, v144
    s_nop 0
    s_waitcnt lgkmcnt(10)
    v_mfma_f32_32x32x16_bf16 v[160:175], v[52:55], v[196:199], v[160:175]
    ds_read_b128 v[192:195], v10 offset:40960
    v_cvt_pk_bf16_f32 v144, v144, v144
    v_and_b32 v144, 0xffff0000, v144
    buffer_store_dword v144, v6, s[4:7], 0 offen offset:128 sc1
    s_waitcnt lgkmcnt(10)
    v_mfma_f32_32x32x16_bf16 v[160:175], v[56:59], v[200:203], v[160:175]
    ds_read_b128 v[196:199], v11 offset:40960
    s_waitcnt lgkmcnt(10)
    v_mfma_f32_32x32x16_bf16 v[160:175], v[60:63], v[204:207], v[160:175]
    ds_read_b128 v[200:203], v12 offset:40960
    s_waitcnt lgkmcnt(10)
    v_mfma_f32_32x32x16_bf16 v[160:175], v[64:67], v[208:211], v[160:175]
    ds_read_b128 v[204:207], v13 offset:40960
    s_waitcnt lgkmcnt(10)
    v_mfma_f32_32x32x16_bf16 v[160:175], v[68:71], v[212:215], v[160:175]
    ds_read_b128 v[208:211], v10 offset:45056
    s_waitcnt lgkmcnt(10)
    v_mfma_f32_32x32x16_bf16 v[160:175], v[72:75], v[216:219], v[160:175]
    ds_read_b128 v[212:215], v11 offset:45056
    s_waitcnt lgkmcnt(10)
    v_mfma_f32_32x32x16_bf16 v[160:175], v[76:79], v[220:223], v[160:175]
    ds_read_b128 v[216:219], v12 offset:45056
    s_waitcnt lgkmcnt(10)
    v_mfma_f32_32x32x16_bf16 v[160:175], v[80:83], v[176:179], v[160:175]
    ds_read_b128 v[220:223], v13 offset:45056
    s_waitcnt lgkmcnt(10)
    v_mfma_f32_32x32x16_bf16 v[160:175], v[84:87], v[180:183], v[160:175]
    s_waitcnt lgkmcnt(9)
    v_mfma_f32_32x32x16_bf16 v[160:175], v[88:91], v[184:187], v[160:175]
    s_waitcnt lgkmcnt(8)
    v_mfma_f32_32x32x16_bf16 v[160:175], v[92:95], v[188:191], v[160:175]
    s_waitcnt lgkmcnt(7)
    v_mfma_f32_32x32x16_bf16 v[160:175], v[96:99], v[192:195], v[160:175]
    s_waitcnt lgkmcnt(6)
    v_mfma_f32_32x32x16_bf16 v[160:175], v[100:103], v[196:199], v[160:175]
    s_waitcnt lgkmcnt(5)
    v_mfma_f32_32x32x16_bf16 v[160:175], v[104:107], v[200:203], v[160:175]
    s_waitcnt lgkmcnt(4)
    v_mfma_f32_32x32x16_bf16 v[160:175], v[108:111], v[204:207], v[160:175]
    s_waitcnt lgkmcnt(3)
    v_mfma_f32_32x32x16_bf16 v[160:175], v[112:115], v[208:211], v[160:175]
    s_waitcnt lgkmcnt(2)
    v_mfma_f32_32x32x16_bf16 v[160:175], v[116:119], v[212:215], v[160:175]
    s_waitcnt lgkmcnt(1)
    v_mfma_f32_32x32x16_bf16 v[160:175], v[120:123], v[216:219], v[160:175]
    s_waitcnt lgkmcnt(0)
    v_mfma_f32_32x32x16_bf16 v[160:175], v[124:127], v[220:223], v[160:175]
    s_nop 11
    v_cvt_pk_bf16_f32 v160, v160, v160
    v_and_b32 v160, 0xffff0000, v160
    v_mul_f32 v160, 0xbfb8aa3b, v160
    v_exp_f32 v160, v160
    s_nop 0
    v_add_f32 v160, 1.0, v160
    v_rcp_f32 v160, v160
    s_nop 0
    v_cvt_pk_bf16_f32 v160, v160, v160
    v_and_b32 v160, 0xffff0000, v160
    buffer_store_dword v160, v6, s[4:7], 0 offen offset:256 sc1
    s_branch L_signal
L_v:
    v_lshl_add_u32 v8, v17, 3, v8
    s_lshl_b32 s40, s52, 9
    v_mul_u32_u24 v6, 7168, v2
    v_lshl_add_u32 v6, v1, 4, v6
    v_add_u32 v6, s40, v6
    v_add_u32 v7, 14336, v6
    s_waitcnt vmcnt(10) lgkmcnt(0)
    s_barrier
    ds_read_b64_tr_b16 v[16:17], v8 offset:0
    ds_read_b64_tr_b16 v[18:19], v8 offset:1024
    ds_read_b128 v[176:179], v3 offset:0
    ds_read_b128 v[180:183], v3 offset:4096
    ds_read_b128 v[184:187], v3 offset:8192
    ds_read_b64_tr_b16 v[20:21], v8 offset:4096
    ds_read_b64_tr_b16 v[22:23], v8 offset:5120
    ds_read_b128 v[188:191], v4 offset:0
    ds_read_b128 v[192:195], v4 offset:4096
    ds_read_b128 v[196:199], v4 offset:8192
    ds_read_b64_tr_b16 v[24:25], v8 offset:8192
    ds_read_b64_tr_b16 v[26:27], v8 offset:9216
    ds_read_b128 v[200:203], v5 offset:0
    ds_read_b128 v[204:207], v5 offset:4096
    ds_read_b128 v[208:211], v5 offset:8192
    s_add_u32 s59, s57, 3
    s_sub_u32 s58, s59, 7
    s_min_u32 s59, s59, s58
    s_mul_i32 s58, s59, 172032
    s_lshl_b32 s59, s59, 7
    s_add_u32 m0, s45, 62848
    s_add_u32 s40, s58, 0
    buffer_load_dwordx4 v229, s[32:35], s40 offen lds
    s_add_u32 m0, s45, 79232
    s_add_u32 s41, s59, 0
    buffer_load_dwordx4 v252, s[28:31], s41 offen lds
    s_waitcnt lgkmcnt(10)
    v_mfma_f32_32x32x16_bf16 v[128:143], v[176:179], v[16:19], 0
    ds_read_b64_tr_b16 v[28:29], v8 offset:12288
    ds_read_b64_tr_b16 v[30:31], v8 offset:13312
    ds_read_b128 v[212:215], v15 offset:0
    s_add_u32 m0, s45, 66944
    s_add_u32 s40, s58, 43008
    buffer_load_dwordx4 v229, s[32:35], s40 offen lds
    v_mfma_f32_32x32x16_bf16 v[144:159], v[180:183], v[16:19], 0
    ds_read_b128 v[216:219], v15 offset:4096
    ds_read_b128 v[220:223], v15 offset:8192
    v_subrev_u32 v3, 20480, v3
    v_subrev_u32 v4, 20480, v4
    v_subrev_u32 v5, 20480, v5
    v_subrev_u32 v15, 20480, v15
    v_subrev_u32 v8, 20480, v8
    s_add_u32 m0, s45, 71040
    s_add_u32 s40, s58, 86016
    buffer_load_dwordx4 v229, s[32:35], s40 offen lds
    v_mfma_f32_32x32x16_bf16 v[160:175], v[184:187], v[16:19], 0
    s_add_u32 m0, s45, 75136
    s_add_u32 s40, s58, 129024
    buffer_load_dwordx4 v229, s[32:35], s40 offen lds
    s_waitcnt lgkmcnt(10)
    v_mfma_f32_32x32x16_bf16 v[128:143], v[188:191], v[20:23], v[128:143]
    s_add_u32 s59, s57, 4
    s_sub_u32 s58, s59, 7
    s_min_u32 s59, s59, s58
    s_mul_i32 s58, s59, 172032
    s_lshl_b32 s59, s59, 7
    s_add_u32 m0, s45, 42368
    s_add_u32 s40, s58, 0
    buffer_load_dwordx4 v229, s[32:35], s40 offen lds
    v_mfma_f32_32x32x16_bf16 v[144:159], v[192:195], v[20:23], v[144:159]
    s_add_u32 m0, s45, 58752
    s_add_u32 s41, s59, 0
    buffer_load_dwordx4 v252, s[28:31], s41 offen lds
    v_mfma_f32_32x32x16_bf16 v[160:175], v[196:199], v[20:23], v[160:175]
    s_add_u32 m0, s45, 46464
    s_add_u32 s40, s58, 43008
    buffer_load_dwordx4 v229, s[32:35], s40 offen lds
    s_waitcnt lgkmcnt(5)
    v_mfma_f32_32x32x16_bf16 v[128:143], v[200:203], v[24:27], v[128:143]
    s_add_u32 m0, s45, 50560
    s_add_u32 s40, s58, 86016
    buffer_load_dwordx4 v229, s[32:35], s40 offen lds
    v_mfma_f32_32x32x16_bf16 v[144:159], v[204:207], v[24:27], v[144:159]
    s_add_u32 m0, s45, 54656
    s_add_u32 s40, s58, 129024
    buffer_load_dwordx4 v229, s[32:35], s40 offen lds
    v_mfma_f32_32x32x16_bf16 v[160:175], v[208:211], v[24:27], v[160:175]
    s_waitcnt lgkmcnt(0)
    v_mfma_f32_32x32x16_bf16 v[128:143], v[212:215], v[28:31], v[128:143]
    v_mfma_f32_32x32x16_bf16 v[144:159], v[216:219], v[28:31], v[144:159]
    v_mfma_f32_32x32x16_bf16 v[160:175], v[220:223], v[28:31], v[160:175]
    s_waitcnt vmcnt(10)
    s_barrier
    ds_read_b64_tr_b16 v[32:33], v8 offset:49152
    ds_read_b64_tr_b16 v[34:35], v8 offset:50176
    ds_read_b128 v[176:179], v3 offset:49152
    ds_read_b64_tr_b16 v[36:37], v8 offset:53248
    ds_read_b64_tr_b16 v[38:39], v8 offset:54272
    ds_read_b128 v[180:183], v4 offset:49152
    ds_read_b64_tr_b16 v[40:41], v8 offset:57344
    ds_read_b64_tr_b16 v[42:43], v8 offset:58368
    ds_read_b128 v[184:187], v5 offset:49152
    ds_read_b64_tr_b16 v[44:45], v8 offset:61440
    ds_read_b64_tr_b16 v[46:47], v8 offset:62464
    ds_read_b128 v[188:191], v15 offset:49152
    ds_read_b64_tr_b16 v[48:49], v8 offset:0
    ds_read_b64_tr_b16 v[50:51], v8 offset:1024
    ds_read_b128 v[192:195], v3 offset:0
    s_add_u32 s59, s57, 5
    s_sub_u32 s58, s59, 7
    s_min_u32 s59, s59, s58
    s_mul_i32 s58, s59, 172032
    s_lshl_b32 s59, s59, 7
    s_add_u32 m0, s45, 21888
    s_add_u32 s40, s58, 0
    buffer_load_dwordx4 v229, s[32:35], s40 offen lds
    s_add_u32 m0, s45, 38272
    s_add_u32 s41, s59, 0
    buffer_load_dwordx4 v252, s[28:31], s41 offen lds
    s_waitcnt lgkmcnt(12)
    v_mfma_f32_32x32x16_bf16 v[128:143], v[176:179], v[32:35], v[128:143]
    ds_read_b64_tr_b16 v[52:53], v8 offset:4096
    ds_read_b64_tr_b16 v[54:55], v8 offset:5120
    ds_read_b128 v[196:199], v4 offset:0
    s_add_u32 m0, s45, 25984
    s_add_u32 s40, s58, 43008
    buffer_load_dwordx4 v229, s[32:35], s40 offen lds
    s_add_u32 m0, s45, 30080
    s_add_u32 s40, s58, 86016
    buffer_load_dwordx4 v229, s[32:35], s40 offen lds
    s_waitcnt lgkmcnt(12)
    v_mfma_f32_32x32x16_bf16 v[128:143], v[180:183], v[36:39], v[128:143]
    ds_read_b64_tr_b16 v[56:57], v8 offset:8192
    ds_read_b64_tr_b16 v[58:59], v8 offset:9216
    ds_read_b128 v[200:203], v5 offset:0
    s_add_u32 m0, s45, 34176
    s_add_u32 s40, s58, 129024
    buffer_load_dwordx4 v229, s[32:35], s40 offen lds
    s_add_u32 s59, s57, 6
    s_sub_u32 s58, s59, 7
    s_min_u32 s59, s59, s58
    s_mul_i32 s58, s59, 172032
    s_lshl_b32 s59, s59, 7
    s_add_u32 m0, s45, 1408
    s_add_u32 s40, s58, 0
    buffer_load_dwordx4 v229, s[32:35], s40 offen lds
    s_waitcnt lgkmcnt(12)
    v_mfma_f32_32x32x16_bf16 v[128:143], v[184:187], v[40:43], v[128:143]
    ds_read_b64_tr_b16 v[60:61], v8 offset:12288
    ds_read_b64_tr_b16 v[62:63], v8 offset:13312
    ds_read_b128 v[204:207], v15 offset:0
    v_subrev_u32 v3, 40960, v3
    v_subrev_u32 v4, 40960, v4
    v_subrev_u32 v5, 40960, v5
    v_subrev_u32 v15, 40960, v15
    v_subrev_u32 v8, 40960, v8
    s_add_u32 m0, s45, 17792
    s_add_u32 s41, s59, 0
    buffer_load_dwordx4 v252, s[28:31], s41 offen lds
    s_add_u32 m0, s45, 5504
    s_add_u32 s40, s58, 43008
    buffer_load_dwordx4 v229, s[32:35], s40 offen lds
    s_waitcnt lgkmcnt(12)
    v_mfma_f32_32x32x16_bf16 v[128:143], v[188:191], v[44:47], v[128:143]
    s_add_u32 m0, s45, 9600
    s_add_u32 s40, s58, 86016
    buffer_load_dwordx4 v229, s[32:35], s40 offen lds
    s_add_u32 m0, s45, 13696
    s_add_u32 s40, s58, 129024
    buffer_load_dwordx4 v229, s[32:35], s40 offen lds
    s_waitcnt lgkmcnt(9)
    v_mfma_f32_32x32x16_bf16 v[128:143], v[192:195], v[48:51], v[128:143]
    s_add_u32 s59, s57, 1
    s_sub_u32 s58, s59, 7
    s_min_u32 s59, s59, s58
    s_lshl_b32 s59, s59, 7
    s_add_u32 m0, s45, 107904
    s_add_u32 s41, s59, 28672
    buffer_load_dwordx4 v252, s[28:31], s41 offen lds
    s_add_u32 s59, s57, 2
    s_sub_u32 s58, s59, 7
    s_min_u32 s59, s59, s58
    s_lshl_b32 s59, s59, 7
    s_add_u32 m0, s45, 112000
    s_add_u32 s41, s59, 28672
    buffer_load_dwordx4 v252, s[28:31], s41 offen lds
    s_waitcnt lgkmcnt(6)
    v_mfma_f32_32x32x16_bf16 v[128:143], v[196:199], v[52:55], v[128:143]
    s_add_u32 s59, s57, 3
    s_sub_u32 s58, s59, 7
    s_min_u32 s59, s59, s58
    s_lshl_b32 s59, s59, 7
    s_add_u32 m0, s45, 116096
    s_add_u32 s41, s59, 28672
    buffer_load_dwordx4 v252, s[28:31], s41 offen lds
    s_add_u32 s59, s57, 4
    s_sub_u32 s58, s59, 7
    s_min_u32 s59, s59, s58
    s_lshl_b32 s59, s59, 7
    s_add_u32 m0, s45, 120192
    s_add_u32 s41, s59, 28672
    buffer_load_dwordx4 v252, s[28:31], s41 offen lds
    s_waitcnt lgkmcnt(3)
    v_mfma_f32_32x32x16_bf16 v[128:143], v[200:203], v[56:59], v[128:143]
    s_add_u32 s59, s57, 5
    s_sub_u32 s58, s59, 7
    s_min_u32 s59, s59, s58
    s_lshl_b32 s59, s59, 7
    s_add_u32 m0, s45, 124288
    s_add_u32 s41, s59, 28672
    buffer_load_dwordx4 v252, s[28:31], s41 offen lds
    s_add_u32 s59, s57, 6
    s_sub_u32 s58, s59, 7
    s_min_u32 s59, s59, s58
    s_lshl_b32 s59, s59, 7
    s_add_u32 m0, s45, 128384
    s_add_u32 s41, s59, 28672
    buffer_load_dwordx4 v252, s[28:31], s41 offen lds
    s_waitcnt lgkmcnt(0)
    v_mfma_f32_32x32x16_bf16 v[128:143], v[204:207], v[60:63], v[128:143]
    s_waitcnt vmcnt(16)
    s_barrier
    ds_read_b64_tr_b16 v[64:65], v8 offset:20480
    ds_read_b64_tr_b16 v[66:67], v8 offset:21504
    ds_read_b128 v[208:211], v3 offset:20480
    ds_read_b64_tr_b16 v[68:69], v8 offset:24576
    ds_read_b64_tr_b16 v[70:71], v8 offset:25600
    ds_read_b128 v[212:215], v4 offset:20480
    ds_read_b64_tr_b16 v[72:73], v8 offset:28672
    ds_read_b64_tr_b16 v[74:75], v8 offset:29696
    ds_read_b128 v[216:219], v5 offset:20480
    ds_read_b64_tr_b16 v[76:77], v8 offset:32768
    ds_read_b64_tr_b16 v[78:79], v8 offset:33792
    ds_read_b128 v[220:223], v15 offset:20480
    ds_read_b64_tr_b16 v[80:81], v8 offset:0
    ds_read_b64_tr_b16 v[82:83], v8 offset:1024
    ds_read_b128 v[176:179], v3 offset:0
    s_waitcnt lgkmcnt(12)
    v_mfma_f32_32x32x16_bf16 v[128:143], v[208:211], v[64:67], v[128:143]
    ds_read_b64_tr_b16 v[84:85], v8 offset:4096
    ds_read_b64_tr_b16 v[86:87], v8 offset:5120
    ds_read_b128 v[180:183], v4 offset:0
    s_waitcnt lgkmcnt(12)
    v_mfma_f32_32x32x16_bf16 v[128:143], v[212:215], v[68:71], v[128:143]
    ds_read_b64_tr_b16 v[88:89], v8 offset:8192
    ds_read_b64_tr_b16 v[90:91], v8 offset:9216
    ds_read_b128 v[184:187], v5 offset:0
    s_waitcnt lgkmcnt(12)
    v_mfma_f32_32x32x16_bf16 v[128:143], v[216:219], v[72:75], v[128:143]
    ds_read_b64_tr_b16 v[92:93], v8 offset:12288
    ds_read_b64_tr_b16 v[94:95], v8 offset:13312
    ds_read_b128 v[188:191], v15 offset:0
    v_subrev_u32 v3, 40960, v3
    v_subrev_u32 v4, 40960, v4
    v_subrev_u32 v5, 40960, v5
    v_subrev_u32 v15, 40960, v15
    v_subrev_u32 v8, 40960, v8
    s_waitcnt lgkmcnt(12)
    v_mfma_f32_32x32x16_bf16 v[128:143], v[220:223], v[76:79], v[128:143]
    s_waitcnt lgkmcnt(9)
    v_mfma_f32_32x32x16_bf16 v[128:143], v[176:179], v[80:83], v[128:143]
    s_waitcnt lgkmcnt(6)
    v_mfma_f32_32x32x16_bf16 v[128:143], v[180:183], v[84:87], v[128:143]
    s_waitcnt lgkmcnt(3)
    v_mfma_f32_32x32x16_bf16 v[128:143], v[184:187], v[88:91], v[128:143]
    s_waitcnt lgkmcnt(0)
    v_mfma_f32_32x32x16_bf16 v[128:143], v[188:191], v[92:95], v[128:143]
    s_waitcnt vmcnt(6)
    s_barrier
    ds_read_b64_tr_b16 v[96:97], v8 offset:20480
    ds_read_b64_tr_b16 v[98:99], v8 offset:21504
    ds_read_b128 v[192:195], v3 offset:20480
    ds_read_b64_tr_b16 v[100:101], v8 offset:24576
    ds_read_b64_tr_b16 v[102:103], v8 offset:25600
    ds_read_b128 v[196:199], v4 offset:20480
    ds_read_b64_tr_b16 v[104:105], v8 offset:28672
    ds_read_b64_tr_b16 v[106:107], v8 offset:29696
    ds_read_b128 v[200:203], v5 offset:20480
    ds_read_b64_tr_b16 v[108:109], v8 offset:32768
    ds_read_b64_tr_b16 v[110:111], v8 offset:33792
    ds_read_b128 v[204:207], v15 offset:20480
    ds_read_b64_tr_b16 v[112:113], v8 offset:0
    ds_read_b64_tr_b16 v[114:115], v8 offset:1024
    ds_read_b128 v[208:211], v3 offset:0
    s_waitcnt lgkmcnt(12)
    v_mfma_f32_32x32x16_bf16 v[128:143], v[192:195], v[96:99], v[128:143]
    ds_read_b64_tr_b16 v[116:117], v8 offset:4096
    ds_read_b64_tr_b16 v[118:119], v8 offset:5120
    ds_read_b128 v[212:215], v4 offset:0
    s_waitcnt lgkmcnt(12)
    v_mfma_f32_32x32x16_bf16 v[128:143], v[196:199], v[100:103], v[128:143]
    ds_read_b64_tr_b16 v[120:121], v8 offset:8192
    ds_read_b64_tr_b16 v[122:123], v8 offset:9216
    ds_read_b128 v[216:219], v5 offset:0
    s_waitcnt lgkmcnt(12)
    v_mfma_f32_32x32x16_bf16 v[128:143], v[200:203], v[104:107], v[128:143]
    ds_read_b64_tr_b16 v[124:125], v8 offset:12288
    ds_read_b64_tr_b16 v[126:127], v8 offset:13312
    ds_read_b128 v[220:223], v15 offset:0
    s_waitcnt lgkmcnt(12)
    v_mfma_f32_32x32x16_bf16 v[128:143], v[204:207], v[108:111], v[128:143]
    s_waitcnt lgkmcnt(9)
    s_waitcnt lgkmcnt(0)
    s_waitcnt vmcnt(0)
    s_barrier
    ds_read_b128 v[176:179], v10 offset:0
    ds_read_b128 v[180:183], v11 offset:0
    v_mfma_f32_32x32x16_bf16 v[128:143], v[208:211], v[112:115], v[128:143]
    ds_read_b128 v[184:187], v12 offset:0
    ds_read_b128 v[188:191], v13 offset:0
    v_mfma_f32_32x32x16_bf16 v[128:143], v[212:215], v[116:119], v[128:143]
    ds_read_b128 v[192:195], v10 offset:4096
    ds_read_b128 v[196:199], v11 offset:4096
    v_mfma_f32_32x32x16_bf16 v[128:143], v[216:219], v[120:123], v[128:143]
    ds_read_b128 v[200:203], v12 offset:4096
    ds_read_b128 v[204:207], v13 offset:4096
    v_mfma_f32_32x32x16_bf16 v[128:143], v[220:223], v[124:127], v[128:143]
    s_waitcnt lgkmcnt(7)
    v_mfma_f32_32x32x16_bf16 v[144:159], v[176:179], v[32:35], v[144:159]
    ds_read_b128 v[208:211], v10 offset:8192
    s_waitcnt lgkmcnt(7)
    v_mfma_f32_32x32x16_bf16 v[144:159], v[180:183], v[36:39], v[144:159]
    ds_read_b128 v[212:215], v11 offset:8192
    s_waitcnt lgkmcnt(7)
    v_mfma_f32_32x32x16_bf16 v[144:159], v[184:187], v[40:43], v[144:159]
    ds_read_b128 v[216:219], v12 offset:8192
    s_waitcnt lgkmcnt(7)
    v_mfma_f32_32x32x16_bf16 v[144:159], v[188:191], v[44:47], v[144:159]
    ds_read_b128 v[220:223], v13 offset:8192
    v_cvt_pk_bf16_f32 v240, v128, v129
    v_cvt_pk_bf16_f32 v241, v130, v131
    v_cvt_pk_bf16_f32 v242, v132, v133
    v_cvt_pk_bf16_f32 v243, v134, v135
    s_waitcnt lgkmcnt(7)
    v_mfma_f32_32x32x16_bf16 v[144:159], v[192:195], v[48:51], v[144:159]
    ds_read_b128 v[176:179], v10 offset:12288
    buffer_store_dwordx4 v[240:243], v6, s[4:7], s92 offen sc1
    v_cvt_pk_bf16_f32 v244, v136, v137
    v_cvt_pk_bf16_f32 v245, v138, v139
    v_cvt_pk_bf16_f32 v246, v140, v141
    s_waitcnt lgkmcnt(7)
    v_mfma_f32_32x32x16_bf16 v[144:159], v[196:199], v[52:55], v[144:159]
    ds_read_b128 v[180:183], v11 offset:12288
    v_cvt_pk_bf16_f32 v247, v142, v143
    buffer_store_dwordx4 v[244:247], v7, s[4:7], s92 offen sc1
    s_waitcnt lgkmcnt(7)
    v_mfma_f32_32x32x16_bf16 v[144:159], v[200:203], v[56:59], v[144:159]
    ds_read_b128 v[184:187], v12 offset:12288
    s_waitcnt lgkmcnt(7)
    v_mfma_f32_32x32x16_bf16 v[144:159], v[204:207], v[60:63], v[144:159]
    ds_read_b128 v[188:191], v13 offset:12288
    s_waitcnt lgkmcnt(7)
    v_mfma_f32_32x32x16_bf16 v[144:159], v[208:211], v[64:67], v[144:159]
    ds_read_b128 v[192:195], v10 offset:16384
    s_waitcnt lgkmcnt(7)
    v_mfma_f32_32x32x16_bf16 v[144:159], v[212:215], v[68:71], v[144:159]
    ds_read_b128 v[196:199], v11 offset:16384
    s_waitcnt lgkmcnt(7)
    v_mfma_f32_32x32x16_bf16 v[144:159], v[216:219], v[72:75], v[144:159]
    ds_read_b128 v[200:203], v12 offset:16384
    s_waitcnt lgkmcnt(7)
    v_mfma_f32_32x32x16_bf16 v[144:159], v[220:223], v[76:79], v[144:159]
    ds_read_b128 v[204:207], v13 offset:16384
    s_waitcnt lgkmcnt(7)
    v_mfma_f32_32x32x16_bf16 v[144:159], v[176:179], v[80:83], v[144:159]
    ds_read_b128 v[208:211], v10 offset:20480
    s_waitcnt lgkmcnt(7)
    v_mfma_f32_32x32x16_bf16 v[144:159], v[180:183], v[84:87], v[144:159]
    ds_read_b128 v[212:215], v11 offset:20480
    s_waitcnt lgkmcnt(7)
    v_mfma_f32_32x32x16_bf16 v[144:159], v[184:187], v[88:91], v[144:159]
    ds_read_b128 v[216:219], v12 offset:20480
    s_waitcnt lgkmcnt(7)
    v_mfma_f32_32x32x16_bf16 v[144:159], v[188:191], v[92:95], v[144:159]
    ds_read_b128 v[220:223], v13 offset:20480
    s_waitcnt lgkmcnt(7)
    v_mfma_f32_32x32x16_bf16 v[144:159], v[192:195], v[96:99], v[144:159]
    s_waitcnt lgkmcnt(6)
    v_mfma_f32_32x32x16_bf16 v[144:159], v[196:199], v[100:103], v[144:159]
    s_waitcnt lgkmcnt(0)
    s_barrier
    ds_read_b128 v[176:179], v10 offset:24576
    ds_read_b128 v[180:183], v11 offset:24576
    ds_read_b128 v[184:187], v12 offset:24576
    ds_read_b128 v[188:191], v13 offset:24576
    ds_read_b128 v[192:195], v10 offset:28672
    s_waitcnt lgkmcnt(10)
    v_mfma_f32_32x32x16_bf16 v[144:159], v[200:203], v[104:107], v[144:159]
    ds_read_b128 v[196:199], v11 offset:28672
    s_waitcnt lgkmcnt(10)
    v_mfma_f32_32x32x16_bf16 v[144:159], v[204:207], v[108:111], v[144:159]
    ds_read_b128 v[200:203], v12 offset:28672
    s_waitcnt lgkmcnt(10)
    v_mfma_f32_32x32x16_bf16 v[144:159], v[208:211], v[112:115], v[144:159]
    ds_read_b128 v[204:207], v13 offset:28672
    s_waitcnt lgkmcnt(10)
    v_mfma_f32_32x32x16_bf16 v[144:159], v[212:215], v[116:119], v[144:159]
    ds_read_b128 v[208:211], v10 offset:32768
    s_waitcnt lgkmcnt(10)
    v_mfma_f32_32x32x16_bf16 v[144:159], v[216:219], v[120:123], v[144:159]
    ds_read_b128 v[212:215], v11 offset:32768
    s_waitcnt lgkmcnt(10)
    v_mfma_f32_32x32x16_bf16 v[144:159], v[220:223], v[124:127], v[144:159]
    ds_read_b128 v[216:219], v12 offset:32768
    s_waitcnt lgkmcnt(10)
    v_mfma_f32_32x32x16_bf16 v[160:175], v[176:179], v[32:35], v[160:175]
    ds_read_b128 v[220:223], v13 offset:32768
    s_waitcnt lgkmcnt(10)
    v_mfma_f32_32x32x16_bf16 v[160:175], v[180:183], v[36:39], v[160:175]
    ds_read_b128 v[176:179], v10 offset:36864
    s_waitcnt lgkmcnt(10)
    v_mfma_f32_32x32x16_bf16 v[160:175], v[184:187], v[40:43], v[160:175]
    ds_read_b128 v[180:183], v11 offset:36864
    s_waitcnt lgkmcnt(10)
    v_mfma_f32_32x32x16_bf16 v[160:175], v[188:191], v[44:47], v[160:175]
    ds_read_b128 v[184:187], v12 offset:36864
    v_cvt_pk_bf16_f32 v240, v144, v145
    v_cvt_pk_bf16_f32 v241, v146, v147
    v_cvt_pk_bf16_f32 v242, v148, v149
    v_cvt_pk_bf16_f32 v243, v150, v151
    s_waitcnt lgkmcnt(10)
    v_mfma_f32_32x32x16_bf16 v[160:175], v[192:195], v[48:51], v[160:175]
    ds_read_b128 v[188:191], v13 offset:36864
    buffer_store_dwordx4 v[240:243], v6, s[4:7], s93 offen sc1
    v_cvt_pk_bf16_f32 v244, v152, v153
    v_cvt_pk_bf16_f32 v245, v154, v155
    v_cvt_pk_bf16_f32 v246, v156, v157
    s_waitcnt lgkmcnt(10)
    v_mfma_f32_32x32x16_bf16 v[160:175], v[196:199], v[52:55], v[160:175]
    ds_read_b128 v[192:195], v10 offset:40960
    v_cvt_pk_bf16_f32 v247, v158, v159
    buffer_store_dwordx4 v[244:247], v7, s[4:7], s93 offen sc1
    s_waitcnt lgkmcnt(10)
    v_mfma_f32_32x32x16_bf16 v[160:175], v[200:203], v[56:59], v[160:175]
    ds_read_b128 v[196:199], v11 offset:40960
    s_waitcnt lgkmcnt(10)
    v_mfma_f32_32x32x16_bf16 v[160:175], v[204:207], v[60:63], v[160:175]
    ds_read_b128 v[200:203], v12 offset:40960
    s_waitcnt lgkmcnt(10)
    v_mfma_f32_32x32x16_bf16 v[160:175], v[208:211], v[64:67], v[160:175]
    ds_read_b128 v[204:207], v13 offset:40960
    s_waitcnt lgkmcnt(10)
    v_mfma_f32_32x32x16_bf16 v[160:175], v[212:215], v[68:71], v[160:175]
    ds_read_b128 v[208:211], v10 offset:45056
    s_waitcnt lgkmcnt(10)
    v_mfma_f32_32x32x16_bf16 v[160:175], v[216:219], v[72:75], v[160:175]
    ds_read_b128 v[212:215], v11 offset:45056
    s_waitcnt lgkmcnt(10)
    v_mfma_f32_32x32x16_bf16 v[160:175], v[220:223], v[76:79], v[160:175]
    ds_read_b128 v[216:219], v12 offset:45056
    s_waitcnt lgkmcnt(10)
    v_mfma_f32_32x32x16_bf16 v[160:175], v[176:179], v[80:83], v[160:175]
    ds_read_b128 v[220:223], v13 offset:45056
    s_waitcnt lgkmcnt(10)
    v_mfma_f32_32x32x16_bf16 v[160:175], v[180:183], v[84:87], v[160:175]
    s_waitcnt lgkmcnt(9)
    v_mfma_f32_32x32x16_bf16 v[160:175], v[184:187], v[88:91], v[160:175]
    s_waitcnt lgkmcnt(8)
    v_mfma_f32_32x32x16_bf16 v[160:175], v[188:191], v[92:95], v[160:175]
    s_waitcnt lgkmcnt(7)
    v_mfma_f32_32x32x16_bf16 v[160:175], v[192:195], v[96:99], v[160:175]
    s_waitcnt lgkmcnt(6)
    v_mfma_f32_32x32x16_bf16 v[160:175], v[196:199], v[100:103], v[160:175]
    s_waitcnt lgkmcnt(5)
    v_mfma_f32_32x32x16_bf16 v[160:175], v[200:203], v[104:107], v[160:175]
    s_waitcnt lgkmcnt(4)
    v_mfma_f32_32x32x16_bf16 v[160:175], v[204:207], v[108:111], v[160:175]
    s_waitcnt lgkmcnt(3)
    v_mfma_f32_32x32x16_bf16 v[160:175], v[208:211], v[112:115], v[160:175]
    s_waitcnt lgkmcnt(2)
    v_mfma_f32_32x32x16_bf16 v[160:175], v[212:215], v[116:119], v[160:175]
    s_waitcnt lgkmcnt(1)
    v_mfma_f32_32x32x16_bf16 v[160:175], v[216:219], v[120:123], v[160:175]
    s_waitcnt lgkmcnt(0)
    v_mfma_f32_32x32x16_bf16 v[160:175], v[220:223], v[124:127], v[160:175]
    s_nop 11
    v_cvt_pk_bf16_f32 v240, v160, v161
    v_cvt_pk_bf16_f32 v241, v162, v163
    v_cvt_pk_bf16_f32 v242, v164, v165
    v_cvt_pk_bf16_f32 v243, v166, v167
    v_cvt_pk_bf16_f32 v244, v168, v169
    v_cvt_pk_bf16_f32 v245, v170, v171
    v_cvt_pk_bf16_f32 v246, v172, v173
    v_cvt_pk_bf16_f32 v247, v174, v175
L_signal:
    s_setprio 3
    s_waitcnt vmcnt(0)
    s_mov_b64 exec, s[54:55]
    s_cbranch_execz L_nosig
    global_atomic_add v254, v239, s[60:61] sc1
L_nosig:
    s_mov_b64 exec, -1
    s_and_b32 s62, s2, 7
    s_lshl_b32 s62, s62, 1
    s_bfe_u32 s40, s2, 0x10003
    s_add_u32 s62, s62, s40
    s_lshr_b32 s63, s2, 4
    s_mov_b32 s36, s22
    s_mov_b32 s37, s23
    s_mov_b32 s38, 18874368
    s_mov_b32 s39, 0x20000
    s_mul_i32 s40, s62, 7
    s_lshr_b32 s8, s40, 1
    s_mul_i32 s9, s24, 458752
    s_add_u32 s96, s22, s9
    s_addc_u32 s97, s23, 0
    s_lshl_b32 s42, s8, 9
    v_add_u32 v230, s42, v231
    v_add_u32 v224, 2097152, v230
    v_bfe_u32 v20, v0, 2, 1
    v_bfe_u32 v21, v0, 3, 1
    v_and_b32 v22, 19, v0
    v_lshl_add_u32 v22, v20, 3, v22
    v_lshl_add_u32 v22, v21, 2, v22
    v_lshrrev_b32 v18, 5, v0
    v_mul_u32_u24 v19, 7168, v18
    v_lshl_add_u32 v19, v22, 4, v19
    s_lshl_b32 s43, s8, 7
    s_add_u32 s43, s43, 4194304
    v_add_u32 v225, s43, v19
    v_add_u32 v226, 14336, v225
    s_bitcmp1_b32 s62, 0
    s_mov_b32 s20, 0x0fffffff
    s_cselect_b32 s20, 0xfffffff0, s20
    s_cselect_b64 s[18:19], -1, 0
    s_mov_b32 s21, s20
    v_mov_b32 v20, 8388608
    v_cndmask_b32 v225, v20, v225, s[20:21]
    v_cndmask_b32 v226, v20, v226, s[20:21]
    s_add_u32 s43, s24, 1
    s_and_b32 s43, s43, 3
    s_lshl_b32 s40, s63, 2
    s_add_u32 s40, s40, s43
    s_mul_i32 s10, s40, 28672
    s_mul_i32 s43, s43, 12288
    s_add_u32 s43, s43, 83328
    v_add_u32 v248, s43, v231
    s_add_u32 s43, s24, 2
    s_and_b32 s43, s43, 3
    s_lshl_b32 s40, s63, 2
    s_add_u32 s40, s40, s43
    s_mul_i32 s11, s40, 28672
    s_mul_i32 s43, s43, 12288
    s_add_u32 s43, s43, 87424
    v_add_u32 v249, s43, v231
    s_add_u32 s43, s24, 3
    s_and_b32 s43, s43, 3
    s_lshl_b32 s40, s63, 2
    s_add_u32 s40, s40, s43
    s_mul_i32 s12, s40, 28672
    s_mul_i32 s43, s43, 12288
    s_add_u32 s43, s43, 91520
    v_add_u32 v250, s43, v231
    s_add_u32 s43, s24, 4
    s_and_b32 s43, s43, 3
    s_lshl_b32 s40, s63, 2
    s_add_u32 s40, s40, s43
    s_mul_i32 s13, s40, 28672
    s_mul_i32 s43, s43, 12288
    s_add_u32 s43, s43, 83328
    v_add_u32 v236, s43, v231
    s_lshl_b32 s3, s40, 4
    s_add_u32 s3, s3, s62
    s_lshl_b32 s3, s3, 11
    s_add_u32 s3, s3, 12582912
    s_lshl_b32 s40, s40, 8
    s_add_u32 s40, s40, 4
    v_mov_b32 v237, s40
    v_mov_b32 v255, 158080
    s_mov_b32 s14, 0x21800000
    s_mov_b32 s15, 0x5d800000
    s_and_b32 s40, s62, 1
    v_cmp_lt_u32 vcc, v18, s40
    v_cmp_gt_u32 s[100:101], v18, s40
    s_add_u32 s40, s62, 1
    s_and_b32 s40, s40, 6
    v_cndmask_b32 v232, -1, 0, vcc
    v_cndmask_b32 v233, -1, 0, s[100:101]
    s_mov_b64 s[100:101], 0
    s_cmp_eq_u32 s40, 0
    s_cselect_b32 s40, 10, 20
    s_cselect_b32 s41, 2, 4
    s_cselect_b32 s9, 12, 24
    v_mov_b32 v235, s40
    v_writelane_b32 v235, s41, 1
    s_lshl_b32 s40, s62, 2
    s_add_u32 s40, s40, s24
    s_lshl_b32 s40, s40, 8
    s_add_u32 s41, s40, 16
    v_mov_b32 v228, s41
    s_and_b32 s41, s62, 3
    s_lshl_b32 s41, s41, 4
    s_add_u32 s41, s41, s63
    s_lshl_b32 s41, s41, 8
    s_lshr_b32 s42, s62, 2
    s_lshl_b32 s42, s42, 2
    s_add_u32 s41, s41, s42
    s_add_u32 s41, s41, 16384
    v_mov_b32 v234, s40
    v_writelane_b32 v234, s41, 1
    s_mov_b64 exec, 3
    v_mov_b32 v15, 0
    s_mov_b32 s40, 0
L_poll_a:
L_poll1_a:
    global_atomic_add v14, v234, v15, s[60:61] sc0 sc1
    s_add_u32 s40, s40, 1
    s_cmp_ge_u32 s40, 65536
    s_cbranch_scc1 L_give_a
    s_waitcnt vmcnt(0)
    v_cmp_ne_u32 vcc, v235, v14
    s_cbranch_vccnz L_poll_a
L_ok_a:
    s_mov_b64 exec, -1
    global_load_dwordx4 v[160:163], v224, s[96:97] sc1
    global_load_dwordx4 v[164:167], v224, s[96:97] offset:1024 sc1
    buffer_load_dwordx4 v[16:19], v230, s[36:39], s10 offen sc1
    buffer_load_dwordx4 v[20:23], v230, s[36:39], s10 offen offset:1024 sc1
    buffer_load_dwordx4 v[24:27], v230, s[36:39], s11 offen sc1
    buffer_load_dwordx4 v[28:31], v230, s[36:39], s11 offen offset:1024 sc1
    buffer_load_dwordx4 v[32:35], v230, s[36:39], s12 offen sc1
    buffer_load_dwordx4 v[36:39], v230, s[36:39], s12 offen offset:1024 sc1
    global_load_dwordx4 v[168:171], v225, s[96:97] sc1
    global_load_dwordx4 v[172:175], v226, s[96:97] sc1
    s_add_u32 s96, s96, 28672
    s_addc_u32 s97, s97, 0
    buffer_load_dwordx4 v[40:43], v230, s[36:39], s13 offen sc1
    buffer_load_dwordx4 v[44:47], v230, s[36:39], s13 offen offset:1024 sc1
    s_waitcnt vmcnt(8)
    v_and_b32 v16, v232, v16
    v_and_b32 v17, v232, v17
    v_and_b32 v22, v233, v22
    v_and_b32 v23, v233, v23
    s_nop 1
    v_mfma_f32_32x32x16_bf16 v[112:127], v[160:163], v[16:19], 0
    global_load_dwordx4 v[176:179], v224, s[96:97] sc1
    v_mfma_f32_32x32x16_bf16 v[112:127], v[164:167], v[20:23], v[112:127]
    global_load_dwordx4 v[180:183], v224, s[96:97] offset:1024 sc1
    s_waitcnt vmcnt(8)
    v_and_b32 v24, v232, v24
    v_and_b32 v25, v232, v25
    v_and_b32 v30, v233, v30
    v_and_b32 v31, v233, v31
    s_setprio 0
    s_nop 3
    v_mfma_f32_32x32x16_bf16 v[128:143], v[160:163], v[24:27], 0
    global_load_dwordx4 v[184:187], v225, s[96:97] sc1
    v_exp_f32 v112, v112
    v_exp_f32 v113, v113
    v_exp_f32 v114, v114
    v_mfma_f32_32x32x16_bf16 v[128:143], v[164:167], v[28:31], v[128:143]
    global_load_dwordx4 v[188:191], v226, s[96:97] sc1
    s_add_u32 s96, s96, 28672
    s_addc_u32 s97, s97, 0
    v_exp_f32 v115, v115
    v_exp_f32 v116, v116
    v_cvt_pk_bf16_f32 v144, v112, v113
    v_cvt_pk_bf16_f32 v145, v114, v115
    s_waitcnt vmcnt(8)
    v_and_b32 v32, v232, v32
    v_and_b32 v33, v232, v33
    v_and_b32 v38, v233, v38
    v_and_b32 v39, v233, v39
    v_exp_f32 v117, v117
    v_exp_f32 v118, v118
    v_exp_f32 v119, v119
    v_exp_f32 v120, v120
    v_cvt_pk_bf16_f32 v146, v116, v117
    v_cvt_pk_bf16_f32 v147, v118, v119
    v_exp_f32 v121, v121
    v_exp_f32 v122, v122
    v_exp_f32 v123, v123
    v_exp_f32 v124, v124
    v_cvt_pk_bf16_f32 v148, v120, v121
    v_cvt_pk_bf16_f32 v149, v122, v123
    v_exp_f32 v125, v125
    v_exp_f32 v126, v126
    v_exp_f32 v127, v127
    v_cvt_pk_bf16_f32 v150, v124, v125
    v_cvt_pk_bf16_f32 v151, v126, v127
    v_mfma_f32_32x32x16_bf16 v[112:127], v[160:163], v[32:35], 0
    global_load_dwordx4 v[192:195], v224, s[96:97] sc1
    v_exp_f32 v128, v128
    v_exp_f32 v129, v129
    v_exp_f32 v130, v130
    v_mfma_f32_32x32x16_bf16 v[112:127], v[164:167], v[36:39], v[112:127]
    global_load_dwordx4 v[196:199], v224, s[96:97] offset:1024 sc1
    v_exp_f32 v131, v131
    v_exp_f32 v132, v132
    v_cvt_pk_bf16_f32 v152, v128, v129
    v_cvt_pk_bf16_f32 v153, v130, v131
    s_waitcnt vmcnt(6)
    v_and_b32 v40, v232, v40
    v_and_b32 v41, v232, v41
    v_and_b32 v46, v233, v46
    v_and_b32 v47, v233, v47
    v_mfma_f32_32x32x16_bf16 v[48:63], v[168:171], v[144:147], 0
    global_load_dwordx4 v[200:203], v225, s[96:97] sc1
    v_exp_f32 v133, v133
    v_exp_f32 v134, v134
    v_exp_f32 v135, v135
    v_mfma_f32_32x32x16_bf16 v[48:63], v[172:175], v[148:151], v[48:63]
    global_load_dwordx4 v[204:207], v226, s[96:97] sc1
    s_add_u32 s96, s96, 28672
    s_addc_u32 s97, s97, 0
    v_exp_f32 v136, v136
    v_cvt_pk_bf16_f32 v154, v132, v133
    v_cvt_pk_bf16_f32 v155, v134, v135
    v_exp_f32 v137, v137
    v_exp_f32 v138, v138
    v_exp_f32 v139, v139
    v_exp_f32 v140, v140
    v_cvt_pk_bf16_f32 v156, v136, v137
    v_cvt_pk_bf16_f32 v157, v138, v139
    v_exp_f32 v141, v141
    v_exp_f32 v142, v142
    v_exp_f32 v143, v143
    v_cvt_pk_bf16_f32 v158, v140, v141
    v_cvt_pk_bf16_f32 v159, v142, v143
    v_mfma_f32_32x32x16_bf16 v[128:143], v[160:163], v[40:43], 0
    global_load_dwordx4 v[208:211], v224, s[96:97] sc1
    v_exp_f32 v112, v112
    v_exp_f32 v113, v113
    v_exp_f32 v114, v114
    v_mfma_f32_32x32x16_bf16 v[128:143], v[164:167], v[44:47], v[128:143]
    global_load_dwordx4 v[212:215], v224, s[96:97] offset:1024 sc1
    v_exp_f32 v115, v115
    v_exp_f32 v116, v116
    v_cvt_pk_bf16_f32 v144, v112, v113
    v_cvt_pk_bf16_f32 v145, v114, v115
    v_mfma_f32_32x32x16_bf16 v[64:79], v[168:171], v[152:155], 0
    global_load_dwordx4 v[216:219], v225, s[96:97] sc1
    v_exp_f32 v117, v117
    v_exp_f32 v118, v118
    v_exp_f32 v119, v119
    v_mfma_f32_32x32x16_bf16 v[64:79], v[172:175], v[156:159], v[64:79]
    global_load_dwordx4 v[220:223], v226, s[96:97] sc1
    s_add_u32 s96, s96, 28672
    s_addc_u32 s97, s97, 0
    s_waitcnt vmcnt(10)
    v_exp_f32 v120, v120
    v_cvt_pk_bf16_f32 v146, v116, v117
    v_cvt_pk_bf16_f32 v147, v118, v119
    v_exp_f32 v121, v121
    v_exp_f32 v122, v122
    v_exp_f32 v123, v123
    v_exp_f32 v124, v124
    v_cvt_pk_bf16_f32 v148, v120, v121
    v_cvt_pk_bf16_f32 v149, v122, v123
    v_exp_f32 v125, v125
    v_exp_f32 v126, v126
    v_exp_f32 v127, v127
    v_cvt_pk_bf16_f32 v150, v124, v125
    v_cvt_pk_bf16_f32 v151, v126, v127
    v_mfma_f32_32x32x16_bf16 v[112:127], v[176:179], v[16:19], 0
    buffer_store_dwordx4 v[240:243], v6, s[4:7], s95 offen sc1
    v_exp_f32 v128, v128
    v_exp_f32 v129, v129
    v_exp_f32 v130, v130
    v_mfma_f32_32x32x16_bf16 v[112:127], v[180:183], v[20:23], v[112:127]
    buffer_store_dwordx4 v[244:247], v7, s[4:7], s95 offen sc1
    v_exp_f32 v131, v131
    v_exp_f32 v132, v132
    v_cvt_pk_bf16_f32 v152, v128, v129
    v_cvt_pk_bf16_f32 v153, v130, v131
    v_mfma_f32_32x32x16_bf16 v[80:95], v[168:171], v[144:147], 0
    v_exp_f32 v133, v133
    v_exp_f32 v134, v134
    v_exp_f32 v135, v135
    v_mfma_f32_32x32x16_bf16 v[80:95], v[172:175], v[148:151], v[80:95]
    s_waitcnt vmcnt(10)
    v_exp_f32 v136, v136
    v_cvt_pk_bf16_f32 v154, v132, v133
    v_cvt_pk_bf16_f32 v155, v134, v135
    v_exp_f32 v137, v137
    v_exp_f32 v138, v138
    v_exp_f32 v139, v139
    v_exp_f32 v140, v140
    v_cvt_pk_bf16_f32 v156, v136, v137
    v_cvt_pk_bf16_f32 v157, v138, v139
    v_exp_f32 v141, v141
    v_exp_f32 v142, v142
    v_exp_f32 v143, v143
    v_cvt_pk_bf16_f32 v158, v140, v141
    v_cvt_pk_bf16_f32 v159, v142, v143
    v_mfma_f32_32x32x16_bf16 v[128:143], v[176:179], v[24:27], 0
    v_exp_f32 v112, v112
    v_exp_f32 v113, v113
    v_exp_f32 v114, v114
    v_mfma_f32_32x32x16_bf16 v[128:143], v[180:183], v[28:31], v[128:143]
    global_load_dwordx4 v[160:163], v224, s[96:97] sc1
    v_exp_f32 v115, v115
    v_exp_f32 v116, v116
    v_cvt_pk_bf16_f32 v144, v112, v113
    v_cvt_pk_bf16_f32 v145, v114, v115
    v_mfma_f32_32x32x16_bf16 v[96:111], v[168:171], v[152:155], 0
    v_exp_f32 v117, v117
    v_exp_f32 v118, v118
    v_exp_f32 v119, v119
    v_mfma_f32_32x32x16_bf16 v[96:111], v[172:175], v[156:159], v[96:111]
    global_load_dwordx4 v[164:167], v224, s[96:97] offset:1024 sc1
    v_exp_f32 v120, v120
    v_cvt_pk_bf16_f32 v146, v116, v117
    v_cvt_pk_bf16_f32 v147, v118, v119
    v_exp_f32 v121, v121
    v_exp_f32 v122, v122
    v_exp_f32 v123, v123
    v_exp_f32 v124, v124
    v_cvt_pk_bf16_f32 v148, v120, v121
    v_cvt_pk_bf16_f32 v149, v122, v123
    v_exp_f32 v125, v125
    v_exp_f32 v126, v126
    v_exp_f32 v127, v127
    v_cvt_pk_bf16_f32 v150, v124, v125
    v_cvt_pk_bf16_f32 v151, v126, v127
    v_mfma_f32_32x32x16_bf16 v[112:127], v[176:179], v[32:35], 0
    v_exp_f32 v128, v128
    v_exp_f32 v129, v129
    v_exp_f32 v130, v130
    v_mfma_f32_32x32x16_bf16 v[112:127], v[180:183], v[36:39], v[112:127]
    global_load_dwordx4 v[168:171], v225, s[96:97] sc1
    v_exp_f32 v131, v131
    v_exp_f32 v132, v132
    v_cvt_pk_bf16_f32 v152, v128, v129
    v_cvt_pk_bf16_f32 v153, v130, v131
    v_mfma_f32_32x32x16_bf16 v[48:63], v[184:187], v[144:147], v[48:63]
    v_exp_f32 v133, v133
    v_exp_f32 v134, v134
    v_exp_f32 v135, v135
    v_mfma_f32_32x32x16_bf16 v[48:63], v[188:191], v[148:151], v[48:63]
    global_load_dwordx4 v[172:175], v226, s[96:97] sc1
    v_exp_f32 v136, v136
    v_cvt_pk_bf16_f32 v154, v132, v133
    v_cvt_pk_bf16_f32 v155, v134, v135
    v_exp_f32 v137, v137
    v_exp_f32 v138, v138
    v_exp_f32 v139, v139
    v_exp_f32 v140, v140
    v_cvt_pk_bf16_f32 v156, v136, v137
    v_cvt_pk_bf16_f32 v157, v138, v139
    v_exp_f32 v141, v141
    v_exp_f32 v142, v142
    v_exp_f32 v143, v143
    v_cvt_pk_bf16_f32 v158, v140, v141
    v_cvt_pk_bf16_f32 v159, v142, v143
    v_mfma_f32_32x32x16_bf16 v[128:143], v[176:179], v[40:43], 0
    s_add_u32 s96, s96, 28672
    v_exp_f32 v112, v112
    v_exp_f32 v113, v113
    v_exp_f32 v114, v114
    v_mfma_f32_32x32x16_bf16 v[128:143], v[180:183], v[44:47], v[128:143]
    s_addc_u32 s97, s97, 0
    v_exp_f32 v115, v115
    v_exp_f32 v116, v116
    v_cvt_pk_bf16_f32 v144, v112, v113
    v_cvt_pk_bf16_f32 v145, v114, v115
    v_mfma_f32_32x32x16_bf16 v[64:79], v[184:187], v[152:155], v[64:79]
    v_exp_f32 v117, v117
    v_exp_f32 v118, v118
    v_exp_f32 v119, v119
    v_mfma_f32_32x32x16_bf16 v[64:79], v[188:191], v[156:159], v[64:79]
    s_waitcnt vmcnt(10)
    v_exp_f32 v120, v120
    v_cvt_pk_bf16_f32 v146, v116, v117
    v_cvt_pk_bf16_f32 v147, v118, v119
    v_exp_f32 v121, v121
    v_exp_f32 v122, v122
    v_exp_f32 v123, v123
    v_exp_f32 v124, v124
    v_cvt_pk_bf16_f32 v148, v120, v121
    v_cvt_pk_bf16_f32 v149, v122, v123
    v_exp_f32 v125, v125
    v_exp_f32 v126, v126
    v_exp_f32 v127, v127
    v_cvt_pk_bf16_f32 v150, v124, v125
    v_cvt_pk_bf16_f32 v151, v126, v127
    v_mfma_f32_32x32x16_bf16 v[112:127], v[192:195], v[16:19], 0
    v_exp_f32 v128, v128
    v_exp_f32 v129, v129
    v_exp_f32 v130, v130
    v_mfma_f32_32x32x16_bf16 v[112:127], v[196:199], v[20:23], v[112:127]
    v_exp_f32 v131, v131
    v_exp_f32 v132, v132
    v_cvt_pk_bf16_f32 v152, v128, v129
    v_cvt_pk_bf16_f32 v153, v130, v131
    v_mfma_f32_32x32x16_bf16 v[80:95], v[184:187], v[144:147], v[80:95]
    v_exp_f32 v133, v133
    v_exp_f32 v134, v134
    v_exp_f32 v135, v135
    v_mfma_f32_32x32x16_bf16 v[80:95], v[188:191], v[148:151], v[80:95]
    v_exp_f32 v136, v136
    v_cvt_pk_bf16_f32 v154, v132, v133
    v_cvt_pk_bf16_f32 v155, v134, v135
    v_exp_f32 v137, v137
    v_exp_f32 v138, v138
    v_exp_f32 v139, v139
    v_exp_f32 v140, v140
    v_cvt_pk_bf16_f32 v156, v136, v137
    v_cvt_pk_bf16_f32 v157, v138, v139
    v_exp_f32 v141, v141
    v_exp_f32 v142, v142
    v_exp_f32 v143, v143
    v_cvt_pk_bf16_f32 v158, v140, v141
    v_cvt_pk_bf16_f32 v159, v142, v143
    v_mfma_f32_32x32x16_bf16 v[128:143], v[192:195], v[24:27], 0
    v_exp_f32 v112, v112
    v_exp_f32 v113, v113
    v_exp_f32 v114, v114
    v_mfma_f32_32x32x16_bf16 v[128:143], v[196:199], v[28:31], v[128:143]
    global_load_dwordx4 v[176:179], v224, s[96:97] sc1
    v_exp_f32 v115, v115
    v_exp_f32 v116, v116
    v_cvt_pk_bf16_f32 v144, v112, v113
    v_cvt_pk_bf16_f32 v145, v114, v115
    v_mfma_f32_32x32x16_bf16 v[96:111], v[184:187], v[152:155], v[96:111]
    v_exp_f32 v117, v117
    v_exp_f32 v118, v118
    v_exp_f32 v119, v119
    v_mfma_f32_32x32x16_bf16 v[96:111], v[188:191], v[156:159], v[96:111]
    global_load_dwordx4 v[180:183], v224, s[96:97] offset:1024 sc1
    v_exp_f32 v120, v120
    v_cvt_pk_bf16_f32 v146, v116, v117
    v_cvt_pk_bf16_f32 v147, v118, v119
    v_exp_f32 v121, v121
    v_exp_f32 v122, v122
    v_exp_f32 v123, v123
    v_exp_f32 v124, v124
    v_cvt_pk_bf16_f32 v148, v120, v121
    v_cvt_pk_bf16_f32 v149, v122, v123
    v_exp_f32 v125, v125
    v_exp_f32 v126, v126
    v_exp_f32 v127, v127
    v_cvt_pk_bf16_f32 v150, v124, v125
    v_cvt_pk_bf16_f32 v151, v126, v127
    v_mfma_f32_32x32x16_bf16 v[112:127], v[192:195], v[32:35], 0
    v_exp_f32 v128, v128
    v_exp_f32 v129, v129
    v_exp_f32 v130, v130
    v_mfma_f32_32x32x16_bf16 v[112:127], v[196:199], v[36:39], v[112:127]
    global_load_dwordx4 v[184:187], v225, s[96:97] sc1
    v_exp_f32 v131, v131
    v_exp_f32 v132, v132
    v_cvt_pk_bf16_f32 v152, v128, v129
    v_cvt_pk_bf16_f32 v153, v130, v131
    v_mfma_f32_32x32x16_bf16 v[48:63], v[200:203], v[144:147], v[48:63]
    v_exp_f32 v133, v133
    v_exp_f32 v134, v134
    v_exp_f32 v135, v135
    v_mfma_f32_32x32x16_bf16 v[48:63], v[204:207], v[148:151], v[48:63]
    global_load_dwordx4 v[188:191], v226, s[96:97] sc1
    v_exp_f32 v136, v136
    v_cvt_pk_bf16_f32 v154, v132, v133
    v_cvt_pk_bf16_f32 v155, v134, v135
    v_exp_f32 v137, v137
    v_exp_f32 v138, v138
    v_exp_f32 v139, v139
    v_exp_f32 v140, v140
    v_cvt_pk_bf16_f32 v156, v136, v137
    v_cvt_pk_bf16_f32 v157, v138, v139
    v_exp_f32 v141, v141
    v_exp_f32 v142, v142
    v_exp_f32 v143, v143
    v_cvt_pk_bf16_f32 v158, v140, v141
    v_cvt_pk_bf16_f32 v159, v142, v143
    v_mfma_f32_32x32x16_bf16 v[128:143], v[192:195], v[40:43], 0
    s_add_u32 s96, s96, 28672
    v_exp_f32 v112, v112
    v_exp_f32 v113, v113
    v_exp_f32 v114, v114
    v_mfma_f32_32x32x16_bf16 v[128:143], v[196:199], v[44:47], v[128:143]
    s_addc_u32 s97, s97, 0
    v_exp_f32 v115, v115
    v_exp_f32 v116, v116
    v_cvt_pk_bf16_f32 v144, v112, v113
    v_cvt_pk_bf16_f32 v145, v114, v115
    v_mfma_f32_32x32x16_bf16 v[64:79], v[200:203], v[152:155], v[64:79]
    v_exp_f32 v117, v117
    v_exp_f32 v118, v118
    v_exp_f32 v119, v119
    v_mfma_f32_32x32x16_bf16 v[64:79], v[204:207], v[156:159], v[64:79]
    s_waitcnt vmcnt(8)
    v_exp_f32 v120, v120
    v_cvt_pk_bf16_f32 v146, v116, v117
    v_cvt_pk_bf16_f32 v147, v118, v119
    v_exp_f32 v121, v121
    v_exp_f32 v122, v122
    v_exp_f32 v123, v123
    v_exp_f32 v124, v124
    v_cvt_pk_bf16_f32 v148, v120, v121
    v_cvt_pk_bf16_f32 v149, v122, v123
    v_exp_f32 v125, v125
    v_exp_f32 v126, v126
    v_exp_f32 v127, v127
    v_cvt_pk_bf16_f32 v150, v124, v125
    v_cvt_pk_bf16_f32 v151, v126, v127
    v_mfma_f32_32x32x16_bf16 v[112:127], v[208:211], v[16:19], 0
    v_exp_f32 v128, v128
    v_exp_f32 v129, v129
    v_exp_f32 v130, v130
    v_mfma_f32_32x32x16_bf16 v[112:127], v[212:215], v[20:23], v[112:127]
    s_mov_b64 exec, s[48:49]
    global_atomic_add v238, v253, s[60:61] sc1
    s_mov_b64 exec, -1
    v_exp_f32 v131, v131
    v_exp_f32 v132, v132
    v_cvt_pk_bf16_f32 v152, v128, v129
    v_cvt_pk_bf16_f32 v153, v130, v131
    v_mfma_f32_32x32x16_bf16 v[80:95], v[200:203], v[144:147], v[80:95]
    v_exp_f32 v133, v133
    v_exp_f32 v134, v134
    v_exp_f32 v135, v135
    v_mfma_f32_32x32x16_bf16 v[80:95], v[204:207], v[148:151], v[80:95]
    v_exp_f32 v136, v136
    v_cvt_pk_bf16_f32 v154, v132, v133
    v_cvt_pk_bf16_f32 v155, v134, v135
    v_exp_f32 v137, v137
    v_exp_f32 v138, v138
    v_exp_f32 v139, v139
    v_exp_f32 v140, v140
    v_cvt_pk_bf16_f32 v156, v136, v137
    v_cvt_pk_bf16_f32 v157, v138, v139
    v_exp_f32 v141, v141
    v_exp_f32 v142, v142
    v_exp_f32 v143, v143
    v_cvt_pk_bf16_f32 v158, v140, v141
    v_cvt_pk_bf16_f32 v159, v142, v143
    v_mfma_f32_32x32x16_bf16 v[128:143], v[208:211], v[24:27], 0
    v_exp_f32 v112, v112
    v_exp_f32 v113, v113
    v_exp_f32 v114, v114
    v_mfma_f32_32x32x16_bf16 v[128:143], v[212:215], v[28:31], v[128:143]
    global_load_dwordx4 v[192:195], v224, s[96:97] sc1
    v_exp_f32 v115, v115
    v_exp_f32 v116, v116
    v_cvt_pk_bf16_f32 v144, v112, v113
    v_cvt_pk_bf16_f32 v145, v114, v115
    v_mfma_f32_32x32x16_bf16 v[96:111], v[200:203], v[152:155], v[96:111]
    v_exp_f32 v117, v117
    v_exp_f32 v118, v118
    v_exp_f32 v119, v119
    v_mfma_f32_32x32x16_bf16 v[96:111], v[204:207], v[156:159], v[96:111]
    global_load_dwordx4 v[196:199], v224, s[96:97] offset:1024 sc1
    v_exp_f32 v120, v120
    v_cvt_pk_bf16_f32 v146, v116, v117
    v_cvt_pk_bf16_f32 v147, v118, v119
    v_exp_f32 v121, v121
    v_exp_f32 v122, v122
    v_exp_f32 v123, v123
    v_exp_f32 v124, v124
    v_cvt_pk_bf16_f32 v148, v120, v121
    v_cvt_pk_bf16_f32 v149, v122, v123
    v_exp_f32 v125, v125
    v_exp_f32 v126, v126
    v_exp_f32 v127, v127
    v_cvt_pk_bf16_f32 v150, v124, v125
    v_cvt_pk_bf16_f32 v151, v126, v127
    v_mfma_f32_32x32x16_bf16 v[112:127], v[208:211], v[32:35], 0
    v_exp_f32 v128, v128
    v_exp_f32 v129, v129
    v_exp_f32 v130, v130
    v_mfma_f32_32x32x16_bf16 v[112:127], v[212:215], v[36:39], v[112:127]
    global_load_dwordx4 v[200:203], v225, s[96:97] sc1
    v_exp_f32 v131, v131
    v_exp_f32 v132, v132
    v_cvt_pk_bf16_f32 v152, v128, v129
    v_cvt_pk_bf16_f32 v153, v130, v131
    v_mfma_f32_32x32x16_bf16 v[48:63], v[216:219], v[144:147], v[48:63]
    v_exp_f32 v133, v133
    v_exp_f32 v134, v134
    v_exp_f32 v135, v135
    v_mfma_f32_32x32x16_bf16 v[48:63], v[220:223], v[148:151], v[48:63]
    global_load_dwordx4 v[204:207], v226, s[96:97] sc1
    v_exp_f32 v136, v136
    v_cvt_pk_bf16_f32 v154, v132, v133
    v_cvt_pk_bf16_f32 v155, v134, v135
    v_exp_f32 v137, v137
    v_exp_f32 v138, v138
    v_exp_f32 v139, v139
    v_exp_f32 v140, v140
    v_cvt_pk_bf16_f32 v156, v136, v137
    v_cvt_pk_bf16_f32 v157, v138, v139
    v_exp_f32 v141, v141
    v_exp_f32 v142, v142
    v_exp_f32 v143, v143
    v_cvt_pk_bf16_f32 v158, v140, v141
    v_cvt_pk_bf16_f32 v159, v142, v143
    v_mfma_f32_32x32x16_bf16 v[128:143], v[208:211], v[40:43], 0
    s_add_u32 s96, s96, 28672
    v_exp_f32 v112, v112
    v_exp_f32 v113, v113
    v_exp_f32 v114, v114
    v_mfma_f32_32x32x16_bf16 v[128:143], v[212:215], v[44:47], v[128:143]
    s_addc_u32 s97, s97, 0
    v_exp_f32 v115, v115
    v_exp_f32 v116, v116
    v_cvt_pk_bf16_f32 v144, v112, v113
    v_cvt_pk_bf16_f32 v145, v114, v115
    v_mfma_f32_32x32x16_bf16 v[64:79], v[216:219], v[152:155], v[64:79]
    v_exp_f32 v117, v117
    v_exp_f32 v118, v118
    v_exp_f32 v119, v119
    v_mfma_f32_32x32x16_bf16 v[64:79], v[220:223], v[156:159], v[64:79]
    s_waitcnt vmcnt(9)
    v_exp_f32 v120, v120
    v_cvt_pk_bf16_f32 v146, v116, v117
    v_cvt_pk_bf16_f32 v147, v118, v119
    v_exp_f32 v121, v121
    v_exp_f32 v122, v122
    v_exp_f32 v123, v123
    v_exp_f32 v124, v124
    v_cvt_pk_bf16_f32 v148, v120, v121
    v_cvt_pk_bf16_f32 v149, v122, v123
    v_exp_f32 v125, v125
    v_exp_f32 v126, v126
    v_exp_f32 v127, v127
    v_cvt_pk_bf16_f32 v150, v124, v125
    v_cvt_pk_bf16_f32 v151, v126, v127
    v_mfma_f32_32x32x16_bf16 v[112:127], v[160:163], v[16:19], 0
    v_exp_f32 v128, v128
    v_exp_f32 v129, v129
    v_exp_f32 v130, v130
    v_mfma_f32_32x32x16_bf16 v[112:127], v[164:167], v[20:23], v[112:127]
    v_exp_f32 v131, v131
    v_exp_f32 v132, v132
    v_cvt_pk_bf16_f32 v152, v128, v129
    v_cvt_pk_bf16_f32 v153, v130, v131
    v_mfma_f32_32x32x16_bf16 v[80:95], v[216:219], v[144:147], v[80:95]
    v_exp_f32 v133, v133
    v_exp_f32 v134, v134
    v_exp_f32 v135, v135
    v_mfma_f32_32x32x16_bf16 v[80:95], v[220:223], v[148:151], v[80:95]
    ds_write_b32 v255, v239 offset:20
    v_exp_f32 v136, v136
    v_cvt_pk_bf16_f32 v154, v132, v133
    v_cvt_pk_bf16_f32 v155, v134, v135
    v_exp_f32 v137, v137
    v_exp_f32 v138, v138
    v_exp_f32 v139, v139
    v_exp_f32 v140, v140
    v_cvt_pk_bf16_f32 v156, v136, v137
    v_cvt_pk_bf16_f32 v157, v138, v139
    v_exp_f32 v141, v141
    v_exp_f32 v142, v142
    v_exp_f32 v143, v143
    v_cvt_pk_bf16_f32 v158, v140, v141
    v_cvt_pk_bf16_f32 v159, v142, v143
    v_mfma_f32_32x32x16_bf16 v[128:143], v[160:163], v[24:27], 0
    v_exp_f32 v112, v112
    v_exp_f32 v113, v113
    v_exp_f32 v114, v114
    v_mfma_f32_32x32x16_bf16 v[128:143], v[164:167], v[28:31], v[128:143]
    global_load_dwordx4 v[208:211], v224, s[96:97] sc1
    v_exp_f32 v115, v115
    v_exp_f32 v116, v116
    v_cvt_pk_bf16_f32 v144, v112, v113
    v_cvt_pk_bf16_f32 v145, v114, v115
    v_mfma_f32_32x32x16_bf16 v[96:111], v[216:219], v[152:155], v[96:111]
    v_exp_f32 v117, v117
    v_exp_f32 v118, v118
    v_exp_f32 v119, v119
    v_mfma_f32_32x32x16_bf16 v[96:111], v[220:223], v[156:159], v[96:111]
    global_load_dwordx4 v[212:215], v224, s[96:97] offset:1024 sc1
    v_exp_f32 v120, v120
    v_cvt_pk_bf16_f32 v146, v116, v117
    v_cvt_pk_bf16_f32 v147, v118, v119
    v_exp_f32 v121, v121
    v_exp_f32 v122, v122
    v_exp_f32 v123, v123
    v_exp_f32 v124, v124
    v_cvt_pk_bf16_f32 v148, v120, v121
    v_cvt_pk_bf16_f32 v149, v122, v123
    v_exp_f32 v125, v125
    v_exp_f32 v126, v126
    v_exp_f32 v127, v127
    v_cvt_pk_bf16_f32 v150, v124, v125
    v_cvt_pk_bf16_f32 v151, v126, v127
    v_mfma_f32_32x32x16_bf16 v[112:127], v[160:163], v[32:35], 0
    v_exp_f32 v128, v128
    v_exp_f32 v129, v129
    v_exp_f32 v130, v130
    v_mfma_f32_32x32x16_bf16 v[112:127], v[164:167], v[36:39], v[112:127]
    global_load_dwordx4 v[216:219], v225, s[96:97] sc1
    v_exp_f32 v131, v131
    v_exp_f32 v132, v132
    v_cvt_pk_bf16_f32 v152, v128, v129
    v_cvt_pk_bf16_f32 v153, v130, v131
    v_mfma_f32_32x32x16_bf16 v[48:63], v[168:171], v[144:147], v[48:63]
    v_exp_f32 v133, v133
    v_exp_f32 v134, v134
    v_exp_f32 v135, v135
    v_mfma_f32_32x32x16_bf16 v[48:63], v[172:175], v[148:151], v[48:63]
    global_load_dwordx4 v[220:223], v226, s[96:97] sc1
    v_exp_f32 v136, v136
    v_cvt_pk_bf16_f32 v154, v132, v133
    v_cvt_pk_bf16_f32 v155, v134, v135
    v_exp_f32 v137, v137
    v_exp_f32 v138, v138
    v_exp_f32 v139, v139
    v_exp_f32 v140, v140
    v_cvt_pk_bf16_f32 v156, v136, v137
    v_cvt_pk_bf16_f32 v157, v138, v139
    v_exp_f32 v141, v141
    v_exp_f32 v142, v142
    v_exp_f32 v143, v143
    v_cvt_pk_bf16_f32 v158, v140, v141
    v_cvt_pk_bf16_f32 v159, v142, v143
    v_mfma_f32_32x32x16_bf16 v[128:143], v[160:163], v[40:43], 0
    s_add_u32 s96, s96, 28672
    v_exp_f32 v112, v112
    v_exp_f32 v113, v113
    v_exp_f32 v114, v114
    v_mfma_f32_32x32x16_bf16 v[128:143], v[164:167], v[44:47], v[128:143]
    s_addc_u32 s97, s97, 0
    v_exp_f32 v115, v115
    v_exp_f32 v116, v116
    v_cvt_pk_bf16_f32 v144, v112, v113
    v_cvt_pk_bf16_f32 v145, v114, v115
    v_mfma_f32_32x32x16_bf16 v[64:79], v[168:171], v[152:155], v[64:79]
    v_exp_f32 v117, v117
    v_exp_f32 v118, v118
    v_exp_f32 v119, v119
    v_mfma_f32_32x32x16_bf16 v[64:79], v[172:175], v[156:159], v[64:79]
    s_waitcnt vmcnt(9)
    v_exp_f32 v120, v120
    v_cvt_pk_bf16_f32 v146, v116, v117
    v_cvt_pk_bf16_f32 v147, v118, v119
    v_exp_f32 v121, v121
    v_exp_f32 v122, v122
    v_exp_f32 v123, v123
    v_exp_f32 v124, v124
    v_cvt_pk_bf16_f32 v148, v120, v121
    v_cvt_pk_bf16_f32 v149, v122, v123
    v_exp_f32 v125, v125
    v_exp_f32 v126, v126
    v_exp_f32 v127, v127
    v_cvt_pk_bf16_f32 v150, v124, v125
    v_cvt_pk_bf16_f32 v151, v126, v127
    v_mfma_f32_32x32x16_bf16 v[112:127], v[176:179], v[16:19], 0
    v_exp_f32 v128, v128
    v_exp_f32 v129, v129
    v_exp_f32 v130, v130
    v_mfma_f32_32x32x16_bf16 v[112:127], v[180:183], v[20:23], v[112:127]
    v_exp_f32 v131, v131
    v_exp_f32 v132, v132
    v_cvt_pk_bf16_f32 v152, v128, v129
    v_cvt_pk_bf16_f32 v153, v130, v131
    v_mfma_f32_32x32x16_bf16 v[80:95], v[168:171], v[144:147], v[80:95]
    v_exp_f32 v133, v133
    v_exp_f32 v134, v134
    v_exp_f32 v135, v135
    v_mfma_f32_32x32x16_bf16 v[80:95], v[172:175], v[148:151], v[80:95]
    v_exp_f32 v136, v136
    v_cvt_pk_bf16_f32 v154, v132, v133
    v_cvt_pk_bf16_f32 v155, v134, v135
    v_exp_f32 v137, v137
    v_exp_f32 v138, v138
    v_exp_f32 v139, v139
    v_exp_f32 v140, v140
    v_cvt_pk_bf16_f32 v156, v136, v137
    v_cvt_pk_bf16_f32 v157, v138, v139
    v_exp_f32 v141, v141
    v_exp_f32 v142, v142
    v_exp_f32 v143, v143
    v_cvt_pk_bf16_f32 v158, v140, v141
    v_cvt_pk_bf16_f32 v159, v142, v143
    v_mfma_f32_32x32x16_bf16 v[128:143], v[176:179], v[24:27], 0
    v_exp_f32 v112, v112
    v_exp_f32 v113, v113
    v_exp_f32 v114, v114
    v_mfma_f32_32x32x16_bf16 v[128:143], v[180:183], v[28:31], v[128:143]
    global_load_dwordx4 v[160:163], v224, s[96:97] sc1
    v_exp_f32 v115, v115
    v_exp_f32 v116, v116
    v_cvt_pk_bf16_f32 v144, v112, v113
    v_cvt_pk_bf16_f32 v145, v114, v115
    v_mfma_f32_32x32x16_bf16 v[96:111], v[168:171], v[152:155], v[96:111]
    v_exp_f32 v117, v117
    v_exp_f32 v118, v118
    v_exp_f32 v119, v119
    v_mfma_f32_32x32x16_bf16 v[96:111], v[172:175], v[156:159], v[96:111]
    global_load_dwordx4 v[164:167], v224, s[96:97] offset:1024 sc1
    v_exp_f32 v120, v120
    v_cvt_pk_bf16_f32 v146, v116, v117
    v_cvt_pk_bf16_f32 v147, v118, v119
    v_exp_f32 v121, v121
    v_exp_f32 v122, v122
    v_exp_f32 v123, v123
    v_exp_f32 v124, v124
    v_cvt_pk_bf16_f32 v148, v120, v121
    v_cvt_pk_bf16_f32 v149, v122, v123
    v_exp_f32 v125, v125
    v_exp_f32 v126, v126
    v_exp_f32 v127, v127
    v_cvt_pk_bf16_f32 v150, v124, v125
    v_cvt_pk_bf16_f32 v151, v126, v127
    v_mfma_f32_32x32x16_bf16 v[112:127], v[176:179], v[32:35], 0
    v_exp_f32 v128, v128
    v_exp_f32 v129, v129
    v_exp_f32 v130, v130
    v_mfma_f32_32x32x16_bf16 v[112:127], v[180:183], v[36:39], v[112:127]
    global_load_dwordx4 v[168:171], v225, s[96:97] sc1
    v_exp_f32 v131, v131
    v_exp_f32 v132, v132
    v_cvt_pk_bf16_f32 v152, v128, v129
    v_cvt_pk_bf16_f32 v153, v130, v131
    v_mfma_f32_32x32x16_bf16 v[48:63], v[184:187], v[144:147], v[48:63]
    v_exp_f32 v133, v133
    v_exp_f32 v134, v134
    v_exp_f32 v135, v135
    v_mfma_f32_32x32x16_bf16 v[48:63], v[188:191], v[148:151], v[48:63]
    global_load_dwordx4 v[172:175], v226, s[96:97] sc1
    v_exp_f32 v136, v136
    v_cvt_pk_bf16_f32 v154, v132, v133
    v_cvt_pk_bf16_f32 v155, v134, v135
    v_exp_f32 v137, v137
    v_exp_f32 v138, v138
    v_exp_f32 v139, v139
    v_exp_f32 v140, v140
    v_cvt_pk_bf16_f32 v156, v136, v137
    v_cvt_pk_bf16_f32 v157, v138, v139
    v_exp_f32 v141, v141
    v_exp_f32 v142, v142
    v_exp_f32 v143, v143
    v_cvt_pk_bf16_f32 v158, v140, v141
    v_cvt_pk_bf16_f32 v159, v142, v143
    v_mfma_f32_32x32x16_bf16 v[128:143], v[176:179], v[40:43], 0
    s_add_u32 s96, s96, 28672
    v_exp_f32 v112, v112
    v_exp_f32 v113, v113
    v_exp_f32 v114, v114
    v_mfma_f32_32x32x16_bf16 v[128:143], v[180:183], v[44:47], v[128:143]
    s_addc_u32 s97, s97, 0
    v_exp_f32 v115, v115
    v_exp_f32 v116, v116
    v_cvt_pk_bf16_f32 v144, v112, v113
    v_cvt_pk_bf16_f32 v145, v114, v115
    v_mfma_f32_32x32x16_bf16 v[64:79], v[184:187], v[152:155], v[64:79]
    v_exp_f32 v117, v117
    v_exp_f32 v118, v118
    v_exp_f32 v119, v119
    v_mfma_f32_32x32x16_bf16 v[64:79], v[188:191], v[156:159], v[64:79]
    s_waitcnt vmcnt(8)
    v_exp_f32 v120, v120
    v_cvt_pk_bf16_f32 v146, v116, v117
    v_cvt_pk_bf16_f32 v147, v118, v119
    v_exp_f32 v121, v121
    v_exp_f32 v122, v122
    v_exp_f32 v123, v123
    v_exp_f32 v124, v124
    v_cvt_pk_bf16_f32 v148, v120, v121
    v_cvt_pk_bf16_f32 v149, v122, v123
    v_exp_f32 v125, v125
    v_exp_f32 v126, v126
    v_exp_f32 v127, v127
    v_cvt_pk_bf16_f32 v150, v124, v125
    v_cvt_pk_bf16_f32 v151, v126, v127
    v_mfma_f32_32x32x16_bf16 v[112:127], v[192:195], v[16:19], 0
    v_exp_f32 v128, v128
    v_exp_f32 v129, v129
    v_exp_f32 v130, v130
    v_mfma_f32_32x32x16_bf16 v[112:127], v[196:199], v[20:23], v[112:127]
    s_mov_b64 exec, 1
    global_atomic_add v14, v228, v15, s[60:61] sc0 sc1
    s_mov_b64 exec, -1
    v_exp_f32 v131, v131
    v_exp_f32 v132, v132
    v_cvt_pk_bf16_f32 v152, v128, v129
    v_cvt_pk_bf16_f32 v153, v130, v131
    v_mfma_f32_32x32x16_bf16 v[80:95], v[184:187], v[144:147], v[80:95]
    v_exp_f32 v133, v133
    v_exp_f32 v134, v134
    v_exp_f32 v135, v135
    v_mfma_f32_32x32x16_bf16 v[80:95], v[188:191], v[148:151], v[80:95]
    v_exp_f32 v136, v136
    v_cvt_pk_bf16_f32 v154, v132, v133
    v_cvt_pk_bf16_f32 v155, v134, v135
    v_exp_f32 v137, v137
    v_exp_f32 v138, v138
    v_exp_f32 v139, v139
    v_exp_f32 v140, v140
    v_cvt_pk_bf16_f32 v156, v136, v137
    v_cvt_pk_bf16_f32 v157, v138, v139
    v_exp_f32 v141, v141
    v_exp_f32 v142, v142
    v_exp_f32 v143, v143
    v_cvt_pk_bf16_f32 v158, v140, v141
    v_cvt_pk_bf16_f32 v159, v142, v143
    v_mfma_f32_32x32x16_bf16 v[128:143], v[192:195], v[24:27], 0
    v_exp_f32 v112, v112
    v_exp_f32 v113, v113
    v_exp_f32 v114, v114
    v_mfma_f32_32x32x16_bf16 v[128:143], v[196:199], v[28:31], v[128:143]
    global_load_dwordx4 v[176:179], v224, s[96:97] sc1
    v_exp_f32 v115, v115
    v_exp_f32 v116, v116
    v_cvt_pk_bf16_f32 v144, v112, v113
    v_cvt_pk_bf16_f32 v145, v114, v115
    v_mfma_f32_32x32x16_bf16 v[96:111], v[184:187], v[152:155], v[96:111]
    v_exp_f32 v117, v117
    v_exp_f32 v118, v118
    v_exp_f32 v119, v119
    v_mfma_f32_32x32x16_bf16 v[96:111], v[188:191], v[156:159], v[96:111]
    global_load_dwordx4 v[180:183], v224, s[96:97] offset:1024 sc1
    v_exp_f32 v120, v120
    v_cvt_pk_bf16_f32 v146, v116, v117
    v_cvt_pk_bf16_f32 v147, v118, v119
    v_exp_f32 v121, v121
    v_exp_f32 v122, v122
    v_exp_f32 v123, v123
    v_exp_f32 v124, v124
    v_cvt_pk_bf16_f32 v148, v120, v121
    v_cvt_pk_bf16_f32 v149, v122, v123
    v_exp_f32 v125, v125
    v_exp_f32 v126, v126
    v_exp_f32 v127, v127
    v_cvt_pk_bf16_f32 v150, v124, v125
    v_cvt_pk_bf16_f32 v151, v126, v127
    v_mfma_f32_32x32x16_bf16 v[112:127], v[192:195], v[32:35], 0
    v_exp_f32 v128, v128
    v_exp_f32 v129, v129
    v_exp_f32 v130, v130
    v_mfma_f32_32x32x16_bf16 v[112:127], v[196:199], v[36:39], v[112:127]
    global_load_dwordx4 v[184:187], v225, s[96:97] sc1
    v_exp_f32 v131, v131
    v_exp_f32 v132, v132
    v_cvt_pk_bf16_f32 v152, v128, v129
    v_cvt_pk_bf16_f32 v153, v130, v131
    v_mfma_f32_32x32x16_bf16 v[48:63], v[200:203], v[144:147], v[48:63]
    v_exp_f32 v133, v133
    v_exp_f32 v134, v134
    v_exp_f32 v135, v135
    v_mfma_f32_32x32x16_bf16 v[48:63], v[204:207], v[148:151], v[48:63]
    global_load_dwordx4 v[188:191], v226, s[96:97] sc1
    v_exp_f32 v136, v136
    v_cvt_pk_bf16_f32 v154, v132, v133
    v_cvt_pk_bf16_f32 v155, v134, v135
    v_exp_f32 v137, v137
    v_exp_f32 v138, v138
    v_exp_f32 v139, v139
    v_exp_f32 v140, v140
    v_cvt_pk_bf16_f32 v156, v136, v137
    v_cvt_pk_bf16_f32 v157, v138, v139
    v_exp_f32 v141, v141
    v_exp_f32 v142, v142
    v_exp_f32 v143, v143
    v_cvt_pk_bf16_f32 v158, v140, v141
    v_cvt_pk_bf16_f32 v159, v142, v143
    v_mfma_f32_32x32x16_bf16 v[128:143], v[192:195], v[40:43], 0
    s_add_u32 s96, s96, 28672
    v_exp_f32 v112, v112
    v_exp_f32 v113, v113
    v_exp_f32 v114, v114
    v_mfma_f32_32x32x16_bf16 v[128:143], v[196:199], v[44:47], v[128:143]
    s_addc_u32 s97, s97, 0
    v_exp_f32 v115, v115
    v_exp_f32 v116, v116
    v_cvt_pk_bf16_f32 v144, v112, v113
    v_cvt_pk_bf16_f32 v145, v114, v115
    v_mfma_f32_32x32x16_bf16 v[64:79], v[200:203], v[152:155], v[64:79]
    v_exp_f32 v117, v117
    v_exp_f32 v118, v118
    v_exp_f32 v119, v119
    v_mfma_f32_32x32x16_bf16 v[64:79], v[204:207], v[156:159], v[64:79]
    s_waitcnt vmcnt(9)
    v_exp_f32 v120, v120
    v_cvt_pk_bf16_f32 v146, v116, v117
    v_cvt_pk_bf16_f32 v147, v118, v119
    v_exp_f32 v121, v121
    v_exp_f32 v122, v122
    v_exp_f32 v123, v123
    v_exp_f32 v124, v124
    v_cvt_pk_bf16_f32 v148, v120, v121
    v_cvt_pk_bf16_f32 v149, v122, v123
    v_exp_f32 v125, v125
    v_exp_f32 v126, v126
    v_exp_f32 v127, v127
    v_cvt_pk_bf16_f32 v150, v124, v125
    v_cvt_pk_bf16_f32 v151, v126, v127
    v_mfma_f32_32x32x16_bf16 v[112:127], v[208:211], v[16:19], 0
    v_exp_f32 v128, v128
    v_exp_f32 v129, v129
    v_exp_f32 v130, v130
    v_mfma_f32_32x32x16_bf16 v[112:127], v[212:215], v[20:23], v[112:127]
    s_waitcnt vmcnt(4)
    v_readfirstlane_b32 s41, v14
    v_exp_f32 v131, v131
    v_exp_f32 v132, v132
    v_cvt_pk_bf16_f32 v152, v128, v129
    v_cvt_pk_bf16_f32 v153, v130, v131
    v_mfma_f32_32x32x16_bf16 v[80:95], v[200:203], v[144:147], v[80:95]
    s_cmp_lg_u32 s41, s9
    v_exp_f32 v133, v133
    v_exp_f32 v134, v134
    v_exp_f32 v135, v135
    v_mfma_f32_32x32x16_bf16 v[80:95], v[204:207], v[148:151], v[80:95]
    s_cbranch_scc1 L_late
L_late_ok:
    v_exp_f32 v136, v136
    v_cvt_pk_bf16_f32 v154, v132, v133
    v_cvt_pk_bf16_f32 v155, v134, v135
    v_exp_f32 v137, v137
    v_exp_f32 v138, v138
    v_exp_f32 v139, v139
    v_exp_f32 v140, v140
    v_cvt_pk_bf16_f32 v156, v136, v137
    v_cvt_pk_bf16_f32 v157, v138, v139
    v_exp_f32 v141, v141
    v_exp_f32 v142, v142
    v_exp_f32 v143, v143
    v_cvt_pk_bf16_f32 v158, v140, v141
    v_cvt_pk_bf16_f32 v159, v142, v143
    v_mfma_f32_32x32x16_bf16 v[128:143], v[208:211], v[24:27], 0
    v_exp_f32 v112, v112
    v_exp_f32 v113, v113
    v_exp_f32 v114, v114
    v_mfma_f32_32x32x16_bf16 v[128:143], v[212:215], v[28:31], v[128:143]
    global_load_dwordx4 v[192:195], v224, s[96:97] sc1
    v_exp_f32 v115, v115
    v_exp_f32 v116, v116
    v_cvt_pk_bf16_f32 v144, v112, v113
    v_cvt_pk_bf16_f32 v145, v114, v115
    v_mfma_f32_32x32x16_bf16 v[96:111], v[200:203], v[152:155], v[96:111]
    v_exp_f32 v117, v117
    v_exp_f32 v118, v118
    v_exp_f32 v119, v119
    v_mfma_f32_32x32x16_bf16 v[96:111], v[204:207], v[156:159], v[96:111]
    global_load_dwordx4 v[196:199], v224, s[96:97] offset:1024 sc1
    v_exp_f32 v120, v120
    v_cvt_pk_bf16_f32 v146, v116, v117
    v_cvt_pk_bf16_f32 v147, v118, v119
    v_exp_f32 v121, v121
    v_exp_f32 v122, v122
    v_exp_f32 v123, v123
    v_exp_f32 v124, v124
    v_cvt_pk_bf16_f32 v148, v120, v121
    v_cvt_pk_bf16_f32 v149, v122, v123
    v_exp_f32 v125, v125
    v_exp_f32 v126, v126
    v_exp_f32 v127, v127
    v_cvt_pk_bf16_f32 v150, v124, v125
    v_cvt_pk_bf16_f32 v151, v126, v127
    v_mfma_f32_32x32x16_bf16 v[112:127], v[208:211], v[32:35], 0
    v_exp_f32 v128, v128
    v_exp_f32 v129, v129
    v_exp_f32 v130, v130
    v_mfma_f32_32x32x16_bf16 v[112:127], v[212:215], v[36:39], v[112:127]
    global_load_dwordx4 v[200:203], v225, s[96:97] sc1
    v_exp_f32 v131, v131
    v_exp_f32 v132, v132
    v_cvt_pk_bf16_f32 v152, v128, v129
    v_cvt_pk_bf16_f32 v153, v130, v131
    v_mfma_f32_32x32x16_bf16 v[48:63], v[216:219], v[144:147], v[48:63]
    v_exp_f32 v133, v133
    v_exp_f32 v134, v134
    v_exp_f32 v135, v135
    v_mfma_f32_32x32x16_bf16 v[48:63], v[220:223], v[148:151], v[48:63]
    global_load_dwordx4 v[204:207], v226, s[96:97] sc1
    v_exp_f32 v136, v136
    v_cvt_pk_bf16_f32 v154, v132, v133
    v_cvt_pk_bf16_f32 v155, v134, v135
    v_exp_f32 v137, v137
    v_exp_f32 v138, v138
    v_exp_f32 v139, v139
    v_exp_f32 v140, v140
    v_cvt_pk_bf16_f32 v156, v136, v137
    v_cvt_pk_bf16_f32 v157, v138, v139
    v_exp_f32 v141, v141
    v_exp_f32 v142, v142
    v_exp_f32 v143, v143
    v_cvt_pk_bf16_f32 v158, v140, v141
    v_cvt_pk_bf16_f32 v159, v142, v143
    v_mfma_f32_32x32x16_bf16 v[128:143], v[208:211], v[40:43], 0
    s_add_u32 s96, s96, 28672
    v_exp_f32 v112, v112
    v_exp_f32 v113, v113
    v_exp_f32 v114, v114
    v_mfma_f32_32x32x16_bf16 v[128:143], v[212:215], v[44:47], v[128:143]
    s_addc_u32 s97, s97, 0
    v_exp_f32 v115, v115
    v_exp_f32 v116, v116
    v_cvt_pk_bf16_f32 v144, v112, v113
    v_cvt_pk_bf16_f32 v145, v114, v115
    v_mfma_f32_32x32x16_bf16 v[64:79], v[216:219], v[152:155], v[64:79]
    v_exp_f32 v117, v117
    v_exp_f32 v118, v118
    v_exp_f32 v119, v119
    v_mfma_f32_32x32x16_bf16 v[64:79], v[220:223], v[156:159], v[64:79]
    s_waitcnt vmcnt(8)
    v_exp_f32 v120, v120
    v_cvt_pk_bf16_f32 v146, v116, v117
    v_cvt_pk_bf16_f32 v147, v118, v119
    v_exp_f32 v121, v121
    v_exp_f32 v122, v122
    v_exp_f32 v123, v123
    v_exp_f32 v124, v124
    v_cvt_pk_bf16_f32 v148, v120, v121
    v_cvt_pk_bf16_f32 v149, v122, v123
    v_exp_f32 v125, v125
    v_exp_f32 v126, v126
    v_exp_f32 v127, v127
    v_cvt_pk_bf16_f32 v150, v124, v125
    v_cvt_pk_bf16_f32 v151, v126, v127
    v_mfma_f32_32x32x16_bf16 v[112:127], v[160:163], v[16:19], 0
    v_exp_f32 v128, v128
    v_exp_f32 v129, v129
    v_exp_f32 v130, v130
    v_mfma_f32_32x32x16_bf16 v[112:127], v[164:167], v[20:23], v[112:127]
    v_exp_f32 v131, v131
    v_exp_f32 v132, v132
    v_cvt_pk_bf16_f32 v152, v128, v129
    v_cvt_pk_bf16_f32 v153, v130, v131
    v_mfma_f32_32x32x16_bf16 v[80:95], v[216:219], v[144:147], v[80:95]
    v_exp_f32 v133, v133
    v_exp_f32 v134, v134
    v_exp_f32 v135, v135
    v_mfma_f32_32x32x16_bf16 v[80:95], v[220:223], v[148:151], v[80:95]
    v_exp_f32 v136, v136
    v_cvt_pk_bf16_f32 v154, v132, v133
    v_cvt_pk_bf16_f32 v155, v134, v135
    v_exp_f32 v137, v137
    v_exp_f32 v138, v138
    v_exp_f32 v139, v139
    v_exp_f32 v140, v140
    v_cvt_pk_bf16_f32 v156, v136, v137
    v_cvt_pk_bf16_f32 v157, v138, v139
    v_exp_f32 v141, v141
    v_exp_f32 v142, v142
    v_exp_f32 v143, v143
    v_cvt_pk_bf16_f32 v158, v140, v141
    v_cvt_pk_bf16_f32 v159, v142, v143
    v_mfma_f32_32x32x16_bf16 v[128:143], v[160:163], v[24:27], 0
    v_exp_f32 v112, v112
    v_exp_f32 v113, v113
    v_exp_f32 v114, v114
    v_mfma_f32_32x32x16_bf16 v[128:143], v[164:167], v[28:31], v[128:143]
    global_load_dwordx4 v[208:211], v224, s[96:97] sc1
    v_exp_f32 v115, v115
    v_exp_f32 v116, v116
    v_cvt_pk_bf16_f32 v144, v112, v113
    v_cvt_pk_bf16_f32 v145, v114, v115
    v_mfma_f32_32x32x16_bf16 v[96:111], v[216:219], v[152:155], v[96:111]
    v_exp_f32 v117, v117
    v_exp_f32 v118, v118
    v_exp_f32 v119, v119
    v_mfma_f32_32x32x16_bf16 v[96:111], v[220:223], v[156:159], v[96:111]
    global_load_dwordx4 v[212:215], v224, s[96:97] offset:1024 sc1
    v_exp_f32 v120, v120
    v_cvt_pk_bf16_f32 v146, v116, v117
    v_cvt_pk_bf16_f32 v147, v118, v119
    v_exp_f32 v121, v121
    v_exp_f32 v122, v122
    v_exp_f32 v123, v123
    v_exp_f32 v124, v124
    v_cvt_pk_bf16_f32 v148, v120, v121
    v_cvt_pk_bf16_f32 v149, v122, v123
    v_exp_f32 v125, v125
    v_exp_f32 v126, v126
    v_exp_f32 v127, v127
    v_cvt_pk_bf16_f32 v150, v124, v125
    v_cvt_pk_bf16_f32 v151, v126, v127
    v_mfma_f32_32x32x16_bf16 v[112:127], v[160:163], v[32:35], 0
    v_exp_f32 v128, v128
    v_exp_f32 v129, v129
    v_exp_f32 v130, v130
    v_mfma_f32_32x32x16_bf16 v[112:127], v[164:167], v[36:39], v[112:127]
    global_load_dwordx4 v[216:219], v225, s[96:97] sc1
    v_exp_f32 v131, v131
    v_exp_f32 v132, v132
    v_cvt_pk_bf16_f32 v152, v128, v129
    v_cvt_pk_bf16_f32 v153, v130, v131
    v_mfma_f32_32x32x16_bf16 v[48:63], v[168:171], v[144:147], v[48:63]
    v_exp_f32 v133, v133
    v_exp_f32 v134, v134
    v_exp_f32 v135, v135
    v_mfma_f32_32x32x16_bf16 v[48:63], v[172:175], v[148:151], v[48:63]
    global_load_dwordx4 v[220:223], v226, s[96:97] sc1
    v_exp_f32 v136, v136
    v_cvt_pk_bf16_f32 v154, v132, v133
    v_cvt_pk_bf16_f32 v155, v134, v135
    v_exp_f32 v137, v137
    v_exp_f32 v138, v138
    v_exp_f32 v139, v139
    v_exp_f32 v140, v140
    v_cvt_pk_bf16_f32 v156, v136, v137
    v_cvt_pk_bf16_f32 v157, v138, v139
    v_exp_f32 v141, v141
    v_exp_f32 v142, v142
    v_exp_f32 v143, v143
    v_cvt_pk_bf16_f32 v158, v140, v141
    v_cvt_pk_bf16_f32 v159, v142, v143
    v_mfma_f32_32x32x16_bf16 v[128:143], v[160:163], v[40:43], 0
    s_add_u32 s96, s96, 28672
    v_exp_f32 v112, v112
    v_exp_f32 v113, v113
    v_exp_f32 v114, v114
    v_mfma_f32_32x32x16_bf16 v[128:143], v[164:167], v[44:47], v[128:143]
    s_addc_u32 s97, s97, 0
    v_exp_f32 v115, v115
    v_exp_f32 v116, v116
    v_cvt_pk_bf16_f32 v144, v112, v113
    v_cvt_pk_bf16_f32 v145, v114, v115
    v_mfma_f32_32x32x16_bf16 v[64:79], v[168:171], v[152:155], v[64:79]
    v_exp_f32 v117, v117
    v_exp_f32 v118, v118
    v_exp_f32 v119, v119
    v_mfma_f32_32x32x16_bf16 v[64:79], v[172:175], v[156:159], v[64:79]
    s_waitcnt vmcnt(8)
    v_exp_f32 v120, v120
    v_cvt_pk_bf16_f32 v146, v116, v117
    v_cvt_pk_bf16_f32 v147, v118, v119
    v_exp_f32 v121, v121
    v_exp_f32 v122, v122
    v_exp_f32 v123, v123
    v_exp_f32 v124, v124
    v_cvt_pk_bf16_f32 v148, v120, v121
    v_cvt_pk_bf16_f32 v149, v122, v123
    v_exp_f32 v125, v125
    v_exp_f32 v126, v126
    v_exp_f32 v127, v127
    v_cvt_pk_bf16_f32 v150, v124, v125
    v_cvt_pk_bf16_f32 v151, v126, v127
    v_mfma_f32_32x32x16_bf16 v[112:127], v[176:179], v[16:19], 0
    v_exp_f32 v128, v128
    v_exp_f32 v129, v129
    v_exp_f32 v130, v130
    v_mfma_f32_32x32x16_bf16 v[112:127], v[180:183], v[20:23], v[112:127]
    v_exp_f32 v131, v131
    v_exp_f32 v132, v132
    v_cvt_pk_bf16_f32 v152, v128, v129
    v_cvt_pk_bf16_f32 v153, v130, v131
    v_mfma_f32_32x32x16_bf16 v[80:95], v[168:171], v[144:147], v[80:95]
    v_exp_f32 v133, v133
    v_exp_f32 v134, v134
    v_exp_f32 v135, v135
    v_mfma_f32_32x32x16_bf16 v[80:95], v[172:175], v[148:151], v[80:95]
    v_exp_f32 v136, v136
    v_cvt_pk_bf16_f32 v154, v132, v133
    v_cvt_pk_bf16_f32 v155, v134, v135
    v_exp_f32 v137, v137
    v_exp_f32 v138, v138
    v_exp_f32 v139, v139
    v_exp_f32 v140, v140
    v_cvt_pk_bf16_f32 v156, v136, v137
    v_cvt_pk_bf16_f32 v157, v138, v139
    v_exp_f32 v141, v141
    v_exp_f32 v142, v142
    v_exp_f32 v143, v143
    v_cvt_pk_bf16_f32 v158, v140, v141
    v_cvt_pk_bf16_f32 v159, v142, v143
    v_mfma_f32_32x32x16_bf16 v[128:143], v[176:179], v[24:27], 0
    v_exp_f32 v112, v112
    v_exp_f32 v113, v113
    v_exp_f32 v114, v114
    v_mfma_f32_32x32x16_bf16 v[128:143], v[180:183], v[28:31], v[128:143]
    global_load_dwordx4 v[160:163], v224, s[96:97] sc1
    v_exp_f32 v115, v115
    v_exp_f32 v116, v116
    v_cvt_pk_bf16_f32 v144, v112, v113
    v_cvt_pk_bf16_f32 v145, v114, v115
    v_mfma_f32_32x32x16_bf16 v[96:111], v[168:171], v[152:155], v[96:111]
    v_exp_f32 v117, v117
    v_exp_f32 v118, v118
    v_exp_f32 v119, v119
    v_mfma_f32_32x32x16_bf16 v[96:111], v[172:175], v[156:159], v[96:111]
    global_load_dwordx4 v[164:167], v224, s[96:97] offset:1024 sc1
    v_exp_f32 v120, v120
    v_cvt_pk_bf16_f32 v146, v116, v117
    v_cvt_pk_bf16_f32 v147, v118, v119
    v_exp_f32 v121, v121
    v_exp_f32 v122, v122
    v_exp_f32 v123, v123
    v_exp_f32 v124, v124
    v_cvt_pk_bf16_f32 v148, v120, v121
    v_cvt_pk_bf16_f32 v149, v122, v123
    v_exp_f32 v125, v125
    v_exp_f32 v126, v126
    v_exp_f32 v127, v127
    v_cvt_pk_bf16_f32 v150, v124, v125
    v_cvt_pk_bf16_f32 v151, v126, v127
    v_mfma_f32_32x32x16_bf16 v[112:127], v[176:179], v[32:35], 0
    v_exp_f32 v128, v128
    v_exp_f32 v129, v129
    v_exp_f32 v130, v130
    v_mfma_f32_32x32x16_bf16 v[112:127], v[180:183], v[36:39], v[112:127]
    global_load_dwordx4 v[168:171], v225, s[96:97] sc1
    v_exp_f32 v131, v131
    v_exp_f32 v132, v132
    v_cvt_pk_bf16_f32 v152, v128, v129
    v_cvt_pk_bf16_f32 v153, v130, v131
    v_mfma_f32_32x32x16_bf16 v[48:63], v[184:187], v[144:147], v[48:63]
    v_exp_f32 v133, v133
    v_exp_f32 v134, v134
    v_exp_f32 v135, v135
    v_mfma_f32_32x32x16_bf16 v[48:63], v[188:191], v[148:151], v[48:63]
    global_load_dwordx4 v[172:175], v226, s[96:97] sc1
    v_exp_f32 v136, v136
    v_cvt_pk_bf16_f32 v154, v132, v133
    v_cvt_pk_bf16_f32 v155, v134, v135
    v_exp_f32 v137, v137
    v_exp_f32 v138, v138
    v_exp_f32 v139, v139
    v_exp_f32 v140, v140
    v_cvt_pk_bf16_f32 v156, v136, v137
    v_cvt_pk_bf16_f32 v157, v138, v139
    v_exp_f32 v141, v141
    v_exp_f32 v142, v142
    v_exp_f32 v143, v143
    v_cvt_pk_bf16_f32 v158, v140, v141
    v_cvt_pk_bf16_f32 v159, v142, v143
    v_mfma_f32_32x32x16_bf16 v[128:143], v[176:179], v[40:43], 0
    s_add_u32 s96, s96, 28672
    v_exp_f32 v112, v112
    v_exp_f32 v113, v113
    v_exp_f32 v114, v114
    v_mfma_f32_32x32x16_bf16 v[128:143], v[180:183], v[44:47], v[128:143]
    s_addc_u32 s97, s97, 0
    v_exp_f32 v115, v115
    v_exp_f32 v116, v116
    v_cvt_pk_bf16_f32 v144, v112, v113
    v_cvt_pk_bf16_f32 v145, v114, v115
    v_mfma_f32_32x32x16_bf16 v[64:79], v[184:187], v[152:155], v[64:79]
    v_exp_f32 v117, v117
    v_exp_f32 v118, v118
    v_exp_f32 v119, v119
    v_mfma_f32_32x32x16_bf16 v[64:79], v[188:191], v[156:159], v[64:79]
    s_waitcnt vmcnt(8)
    v_exp_f32 v120, v120
    v_cvt_pk_bf16_f32 v146, v116, v117
    v_cvt_pk_bf16_f32 v147, v118, v119
    v_exp_f32 v121, v121
    v_exp_f32 v122, v122
    v_exp_f32 v123, v123
    v_exp_f32 v124, v124
    v_cvt_pk_bf16_f32 v148, v120, v121
    v_cvt_pk_bf16_f32 v149, v122, v123
    v_exp_f32 v125, v125
    v_exp_f32 v126, v126
    v_exp_f32 v127, v127
    v_cvt_pk_bf16_f32 v150, v124, v125
    v_cvt_pk_bf16_f32 v151, v126, v127
    v_mfma_f32_32x32x16_bf16 v[112:127], v[192:195], v[16:19], 0
    v_exp_f32 v128, v128
    v_exp_f32 v129, v129
    v_exp_f32 v130, v130
    v_mfma_f32_32x32x16_bf16 v[112:127], v[196:199], v[20:23], v[112:127]
    v_exp_f32 v131, v131
    v_exp_f32 v132, v132
    v_cvt_pk_bf16_f32 v152, v128, v129
    v_cvt_pk_bf16_f32 v153, v130, v131
    v_mfma_f32_32x32x16_bf16 v[80:95], v[184:187], v[144:147], v[80:95]
    v_exp_f32 v133, v133
    v_exp_f32 v134, v134
    v_exp_f32 v135, v135
    v_mfma_f32_32x32x16_bf16 v[80:95], v[188:191], v[148:151], v[80:95]
    v_exp_f32 v136, v136
    v_cvt_pk_bf16_f32 v154, v132, v133
    v_cvt_pk_bf16_f32 v155, v134, v135
    v_exp_f32 v137, v137
    v_exp_f32 v138, v138
    v_exp_f32 v139, v139
    v_exp_f32 v140, v140
    v_cvt_pk_bf16_f32 v156, v136, v137
    v_cvt_pk_bf16_f32 v157, v138, v139
    v_exp_f32 v141, v141
    v_exp_f32 v142, v142
    v_exp_f32 v143, v143
    v_cvt_pk_bf16_f32 v158, v140, v141
    v_cvt_pk_bf16_f32 v159, v142, v143
    v_mfma_f32_32x32x16_bf16 v[128:143], v[192:195], v[24:27], 0
    v_exp_f32 v112, v112
    v_exp_f32 v113, v113
    v_exp_f32 v114, v114
    v_mfma_f32_32x32x16_bf16 v[128:143], v[196:199], v[28:31], v[128:143]
    global_load_dwordx4 v[176:179], v224, s[96:97] sc1
    v_exp_f32 v115, v115
    v_exp_f32 v116, v116
    v_cvt_pk_bf16_f32 v144, v112, v113
    v_cvt_pk_bf16_f32 v145, v114, v115
    v_mfma_f32_32x32x16_bf16 v[96:111], v[184:187], v[152:155], v[96:111]
    v_exp_f32 v117, v117
    v_exp_f32 v118, v118
    v_exp_f32 v119, v119
    v_mfma_f32_32x32x16_bf16 v[96:111], v[188:191], v[156:159], v[96:111]
    global_load_dwordx4 v[180:183], v224, s[96:97] offset:1024 sc1
    v_exp_f32 v120, v120
    v_cvt_pk_bf16_f32 v146, v116, v117
    v_cvt_pk_bf16_f32 v147, v118, v119
    v_exp_f32 v121, v121
    v_exp_f32 v122, v122
    v_exp_f32 v123, v123
    v_exp_f32 v124, v124
    v_cvt_pk_bf16_f32 v148, v120, v121
    v_cvt_pk_bf16_f32 v149, v122, v123
    v_exp_f32 v125, v125
    v_exp_f32 v126, v126
    v_exp_f32 v127, v127
    v_cvt_pk_bf16_f32 v150, v124, v125
    v_cvt_pk_bf16_f32 v151, v126, v127
    v_mfma_f32_32x32x16_bf16 v[112:127], v[192:195], v[32:35], 0
    v_exp_f32 v128, v128
    v_exp_f32 v129, v129
    v_exp_f32 v130, v130
    v_mfma_f32_32x32x16_bf16 v[112:127], v[196:199], v[36:39], v[112:127]
    global_load_dwordx4 v[184:187], v225, s[96:97] sc1
    v_exp_f32 v131, v131
    v_exp_f32 v132, v132
    v_cvt_pk_bf16_f32 v152, v128, v129
    v_cvt_pk_bf16_f32 v153, v130, v131
    v_mfma_f32_32x32x16_bf16 v[48:63], v[200:203], v[144:147], v[48:63]
    v_exp_f32 v133, v133
    v_exp_f32 v134, v134
    v_exp_f32 v135, v135
    v_mfma_f32_32x32x16_bf16 v[48:63], v[204:207], v[148:151], v[48:63]
    global_load_dwordx4 v[188:191], v226, s[96:97] sc1
    v_exp_f32 v136, v136
    v_cvt_pk_bf16_f32 v154, v132, v133
    v_cvt_pk_bf16_f32 v155, v134, v135
    v_exp_f32 v137, v137
    v_exp_f32 v138, v138
    v_exp_f32 v139, v139
    v_exp_f32 v140, v140
    v_cvt_pk_bf16_f32 v156, v136, v137
    v_cvt_pk_bf16_f32 v157, v138, v139
    v_exp_f32 v141, v141
    v_exp_f32 v142, v142
    v_exp_f32 v143, v143
    v_cvt_pk_bf16_f32 v158, v140, v141
    v_cvt_pk_bf16_f32 v159, v142, v143
    v_mfma_f32_32x32x16_bf16 v[128:143], v[192:195], v[40:43], 0
    s_add_u32 s96, s96, 28672
    v_exp_f32 v112, v112
    v_exp_f32 v113, v113
    v_exp_f32 v114, v114
    v_mfma_f32_32x32x16_bf16 v[128:143], v[196:199], v[44:47], v[128:143]
    s_addc_u32 s97, s97, 0
    v_exp_f32 v115, v115
    v_exp_f32 v116, v116
    v_cvt_pk_bf16_f32 v144, v112, v113
    v_cvt_pk_bf16_f32 v145, v114, v115
    v_mfma_f32_32x32x16_bf16 v[64:79], v[200:203], v[152:155], v[64:79]
    v_exp_f32 v117, v117
    v_exp_f32 v118, v118
    v_exp_f32 v119, v119
    v_mfma_f32_32x32x16_bf16 v[64:79], v[204:207], v[156:159], v[64:79]
    s_waitcnt vmcnt(8)
    v_exp_f32 v120, v120
    v_cvt_pk_bf16_f32 v146, v116, v117
    v_cvt_pk_bf16_f32 v147, v118, v119
    v_exp_f32 v121, v121
    v_exp_f32 v122, v122
    v_exp_f32 v123, v123
    v_exp_f32 v124, v124
    v_cvt_pk_bf16_f32 v148, v120, v121
    v_cvt_pk_bf16_f32 v149, v122, v123
    v_exp_f32 v125, v125
    v_exp_f32 v126, v126
    v_exp_f32 v127, v127
    v_cvt_pk_bf16_f32 v150, v124, v125
    v_cvt_pk_bf16_f32 v151, v126, v127
    v_mfma_f32_32x32x16_bf16 v[112:127], v[208:211], v[16:19], 0
    v_exp_f32 v128, v128
    v_exp_f32 v129, v129
    v_exp_f32 v130, v130
    v_mfma_f32_32x32x16_bf16 v[112:127], v[212:215], v[20:23], v[112:127]
    v_exp_f32 v131, v131
    v_exp_f32 v132, v132
    v_cvt_pk_bf16_f32 v152, v128, v129
    v_cvt_pk_bf16_f32 v153, v130, v131
    v_mfma_f32_32x32x16_bf16 v[80:95], v[200:203], v[144:147], v[80:95]
    v_exp_f32 v133, v133
    v_exp_f32 v134, v134
    v_exp_f32 v135, v135
    v_mfma_f32_32x32x16_bf16 v[80:95], v[204:207], v[148:151], v[80:95]
    v_exp_f32 v136, v136
    v_cvt_pk_bf16_f32 v154, v132, v133
    v_cvt_pk_bf16_f32 v155, v134, v135
    v_exp_f32 v137, v137
    v_exp_f32 v138, v138
    v_exp_f32 v139, v139
    v_exp_f32 v140, v140
    v_cvt_pk_bf16_f32 v156, v136, v137
    v_cvt_pk_bf16_f32 v157, v138, v139
    v_exp_f32 v141, v141
    v_exp_f32 v142, v142
    v_exp_f32 v143, v143
    v_cvt_pk_bf16_f32 v158, v140, v141
    v_cvt_pk_bf16_f32 v159, v142, v143
    v_mfma_f32_32x32x16_bf16 v[128:143], v[208:211], v[24:27], 0
    v_exp_f32 v112, v112
    v_exp_f32 v113, v113
    v_exp_f32 v114, v114
    v_mfma_f32_32x32x16_bf16 v[128:143], v[212:215], v[28:31], v[128:143]
    global_load_dwordx4 v[192:195], v224, s[96:97] sc1
    v_exp_f32 v115, v115
    v_exp_f32 v116, v116
    v_cvt_pk_bf16_f32 v144, v112, v113
    v_cvt_pk_bf16_f32 v145, v114, v115
    v_mfma_f32_32x32x16_bf16 v[96:111], v[200:203], v[152:155], v[96:111]
    v_exp_f32 v117, v117
    v_exp_f32 v118, v118
    v_exp_f32 v119, v119
    v_mfma_f32_32x32x16_bf16 v[96:111], v[204:207], v[156:159], v[96:111]
    global_load_dwordx4 v[196:199], v224, s[96:97] offset:1024 sc1
    v_exp_f32 v120, v120
    v_cvt_pk_bf16_f32 v146, v116, v117
    v_cvt_pk_bf16_f32 v147, v118, v119
    v_exp_f32 v121, v121
    v_exp_f32 v122, v122
    v_exp_f32 v123, v123
    v_exp_f32 v124, v124
    v_cvt_pk_bf16_f32 v148, v120, v121
    v_cvt_pk_bf16_f32 v149, v122, v123
    v_exp_f32 v125, v125
    v_exp_f32 v126, v126
    v_exp_f32 v127, v127
    v_cvt_pk_bf16_f32 v150, v124, v125
    v_cvt_pk_bf16_f32 v151, v126, v127
    v_mfma_f32_32x32x16_bf16 v[112:127], v[208:211], v[32:35], 0
    v_exp_f32 v128, v128
    v_exp_f32 v129, v129
    v_exp_f32 v130, v130
    v_mfma_f32_32x32x16_bf16 v[112:127], v[212:215], v[36:39], v[112:127]
    global_load_dwordx4 v[200:203], v225, s[96:97] sc1
    v_exp_f32 v131, v131
    v_exp_f32 v132, v132
    v_cvt_pk_bf16_f32 v152, v128, v129
    v_cvt_pk_bf16_f32 v153, v130, v131
    v_mfma_f32_32x32x16_bf16 v[48:63], v[216:219], v[144:147], v[48:63]
    v_exp_f32 v133, v133
    v_exp_f32 v134, v134
    v_exp_f32 v135, v135
    v_mfma_f32_32x32x16_bf16 v[48:63], v[220:223], v[148:151], v[48:63]
    global_load_dwordx4 v[204:207], v226, s[96:97] sc1
    v_exp_f32 v136, v136
    v_cvt_pk_bf16_f32 v154, v132, v133
    v_cvt_pk_bf16_f32 v155, v134, v135
    v_exp_f32 v137, v137
    v_exp_f32 v138, v138
    v_exp_f32 v139, v139
    v_exp_f32 v140, v140
    v_cvt_pk_bf16_f32 v156, v136, v137
    v_cvt_pk_bf16_f32 v157, v138, v139
    v_exp_f32 v141, v141
    v_exp_f32 v142, v142
    v_exp_f32 v143, v143
    v_cvt_pk_bf16_f32 v158, v140, v141
    v_cvt_pk_bf16_f32 v159, v142, v143
    v_mfma_f32_32x32x16_bf16 v[128:143], v[208:211], v[40:43], 0
    s_add_u32 s96, s96, 28672
    v_exp_f32 v112, v112
    v_exp_f32 v113, v113
    v_exp_f32 v114, v114
    v_mfma_f32_32x32x16_bf16 v[128:143], v[212:215], v[44:47], v[128:143]
    s_addc_u32 s97, s97, 0
    v_exp_f32 v115, v115
    v_exp_f32 v116, v116
    v_cvt_pk_bf16_f32 v144, v112, v113
    v_cvt_pk_bf16_f32 v145, v114, v115
    v_mfma_f32_32x32x16_bf16 v[64:79], v[216:219], v[152:155], v[64:79]
    v_exp_f32 v117, v117
    v_exp_f32 v118, v118
    v_exp_f32 v119, v119
    v_mfma_f32_32x32x16_bf16 v[64:79], v[220:223], v[156:159], v[64:79]
    s_waitcnt vmcnt(8)
    v_exp_f32 v120, v120
    v_cvt_pk_bf16_f32 v146, v116, v117
    v_cvt_pk_bf16_f32 v147, v118, v119
    v_exp_f32 v121, v121
    v_exp_f32 v122, v122
    v_exp_f32 v123, v123
    v_exp_f32 v124, v124
    v_cvt_pk_bf16_f32 v148, v120, v121
    v_cvt_pk_bf16_f32 v149, v122, v123
    v_exp_f32 v125, v125
    v_exp_f32 v126, v126
    v_exp_f32 v127, v127
    v_cvt_pk_bf16_f32 v150, v124, v125
    v_cvt_pk_bf16_f32 v151, v126, v127
    v_mfma_f32_32x32x16_bf16 v[112:127], v[160:163], v[16:19], 0
    v_exp_f32 v128, v128
    v_exp_f32 v129, v129
    v_exp_f32 v130, v130
    v_mfma_f32_32x32x16_bf16 v[112:127], v[164:167], v[20:23], v[112:127]
    v_exp_f32 v131, v131
    v_exp_f32 v132, v132
    v_cvt_pk_bf16_f32 v152, v128, v129
    v_cvt_pk_bf16_f32 v153, v130, v131
    v_mfma_f32_32x32x16_bf16 v[80:95], v[216:219], v[144:147], v[80:95]
    v_exp_f32 v133, v133
    v_exp_f32 v134, v134
    v_exp_f32 v135, v135
    v_mfma_f32_32x32x16_bf16 v[80:95], v[220:223], v[148:151], v[80:95]
    v_exp_f32 v136, v136
    v_cvt_pk_bf16_f32 v154, v132, v133
    v_cvt_pk_bf16_f32 v155, v134, v135
    v_exp_f32 v137, v137
    v_exp_f32 v138, v138
    v_exp_f32 v139, v139
    v_exp_f32 v140, v140
    v_cvt_pk_bf16_f32 v156, v136, v137
    v_cvt_pk_bf16_f32 v157, v138, v139
    v_exp_f32 v141, v141
    v_exp_f32 v142, v142
    v_exp_f32 v143, v143
    v_cvt_pk_bf16_f32 v158, v140, v141
    v_cvt_pk_bf16_f32 v159, v142, v143
    v_mfma_f32_32x32x16_bf16 v[128:143], v[160:163], v[24:27], 0
    v_exp_f32 v112, v112
    v_exp_f32 v113, v113
    v_exp_f32 v114, v114
    v_mfma_f32_32x32x16_bf16 v[128:143], v[164:167], v[28:31], v[128:143]
    global_load_dwordx4 v[208:211], v224, s[96:97] sc1
    v_exp_f32 v115, v115
    v_exp_f32 v116, v116
    v_cvt_pk_bf16_f32 v144, v112, v113
    v_cvt_pk_bf16_f32 v145, v114, v115
    v_mfma_f32_32x32x16_bf16 v[96:111], v[216:219], v[152:155], v[96:111]
    v_exp_f32 v117, v117
    v_exp_f32 v118, v118
    v_exp_f32 v119, v119
    v_mfma_f32_32x32x16_bf16 v[96:111], v[220:223], v[156:159], v[96:111]
    global_load_dwordx4 v[212:215], v224, s[96:97] offset:1024 sc1
    v_exp_f32 v120, v120
    v_cvt_pk_bf16_f32 v146, v116, v117
    v_cvt_pk_bf16_f32 v147, v118, v119
    v_exp_f32 v121, v121
    v_exp_f32 v122, v122
    v_exp_f32 v123, v123
    v_exp_f32 v124, v124
    v_cvt_pk_bf16_f32 v148, v120, v121
    v_cvt_pk_bf16_f32 v149, v122, v123
    v_exp_f32 v125, v125
    v_exp_f32 v126, v126
    v_exp_f32 v127, v127
    v_cvt_pk_bf16_f32 v150, v124, v125
    v_cvt_pk_bf16_f32 v151, v126, v127
    v_mfma_f32_32x32x16_bf16 v[112:127], v[160:163], v[32:35], 0
    v_exp_f32 v128, v128
    v_exp_f32 v129, v129
    v_exp_f32 v130, v130
    v_mfma_f32_32x32x16_bf16 v[112:127], v[164:167], v[36:39], v[112:127]
    global_load_dwordx4 v[216:219], v225, s[96:97] sc1
    v_exp_f32 v131, v131
    v_exp_f32 v132, v132
    v_cvt_pk_bf16_f32 v152, v128, v129
    v_cvt_pk_bf16_f32 v153, v130, v131
    v_mfma_f32_32x32x16_bf16 v[48:63], v[168:171], v[144:147], v[48:63]
    s_waitcnt vmcnt(7)
    v_exp_f32 v133, v133
    v_exp_f32 v134, v134
    v_exp_f32 v135, v135
    v_mfma_f32_32x32x16_bf16 v[48:63], v[172:175], v[148:151], v[48:63]
    global_load_dwordx4 v[220:223], v226, s[96:97] sc1
    v_exp_f32 v136, v136
    v_cvt_pk_bf16_f32 v154, v132, v133
    v_cvt_pk_bf16_f32 v155, v134, v135
    v_exp_f32 v137, v137
    v_exp_f32 v138, v138
    v_exp_f32 v139, v139
    v_exp_f32 v140, v140
    v_cvt_pk_bf16_f32 v156, v136, v137
    v_cvt_pk_bf16_f32 v157, v138, v139
    v_exp_f32 v141, v141
    v_exp_f32 v142, v142
    v_exp_f32 v143, v143
    v_cvt_pk_bf16_f32 v158, v140, v141
    v_cvt_pk_bf16_f32 v159, v142, v143
    v_mfma_f32_32x32x16_bf16 v[128:143], v[176:179], v[16:19], 0
    s_add_u32 s96, s96, 28672
    v_exp_f32 v112, v112
    v_exp_f32 v113, v113
    v_exp_f32 v114, v114
    v_mfma_f32_32x32x16_bf16 v[128:143], v[180:183], v[20:23], v[128:143]
    s_addc_u32 s97, s97, 0
    v_exp_f32 v115, v115
    v_exp_f32 v116, v116
    v_cvt_pk_bf16_f32 v144, v112, v113
    v_cvt_pk_bf16_f32 v145, v114, v115
    v_mfma_f32_32x32x16_bf16 v[64:79], v[168:171], v[152:155], v[64:79]
    v_exp_f32 v117, v117
    v_exp_f32 v118, v118
    v_exp_f32 v119, v119
    v_mfma_f32_32x32x16_bf16 v[64:79], v[172:175], v[156:159], v[64:79]
    v_exp_f32 v120, v120
    v_cvt_pk_bf16_f32 v146, v116, v117
    v_cvt_pk_bf16_f32 v147, v118, v119
    v_exp_f32 v121, v121
    v_exp_f32 v122, v122
    v_exp_f32 v123, v123
    v_exp_f32 v124, v124
    v_cvt_pk_bf16_f32 v148, v120, v121
    v_cvt_pk_bf16_f32 v149, v122, v123
    v_exp_f32 v125, v125
    v_exp_f32 v126, v126
    v_exp_f32 v127, v127
    v_cvt_pk_bf16_f32 v150, v124, v125
    v_cvt_pk_bf16_f32 v151, v126, v127
    v_mfma_f32_32x32x16_bf16 v[112:127], v[176:179], v[24:27], 0
    v_exp_f32 v128, v128
    v_exp_f32 v129, v129
    v_exp_f32 v130, v130
    v_mfma_f32_32x32x16_bf16 v[112:127], v[180:183], v[28:31], v[112:127]
    v_exp_f32 v131, v131
    v_exp_f32 v132, v132
    v_cvt_pk_bf16_f32 v152, v128, v129
    v_cvt_pk_bf16_f32 v153, v130, v131
    v_mfma_f32_32x32x16_bf16 v[80:95], v[168:171], v[144:147], v[80:95]
    v_exp_f32 v133, v133
    v_exp_f32 v134, v134
    v_exp_f32 v135, v135
    v_mfma_f32_32x32x16_bf16 v[80:95], v[172:175], v[148:151], v[80:95]
    v_exp_f32 v136, v136
    v_cvt_pk_bf16_f32 v154, v132, v133
    v_cvt_pk_bf16_f32 v155, v134, v135
    v_exp_f32 v137, v137
    v_exp_f32 v138, v138
    v_exp_f32 v139, v139
    v_exp_f32 v140, v140
    v_cvt_pk_bf16_f32 v156, v136, v137
    v_cvt_pk_bf16_f32 v157, v138, v139
    v_exp_f32 v141, v141
    v_exp_f32 v142, v142
    v_exp_f32 v143, v143
    v_cvt_pk_bf16_f32 v158, v140, v141
    v_cvt_pk_bf16_f32 v159, v142, v143
    v_mfma_f32_32x32x16_bf16 v[128:143], v[176:179], v[32:35], 0
    v_exp_f32 v112, v112
    v_exp_f32 v113, v113
    v_exp_f32 v114, v114
    v_mfma_f32_32x32x16_bf16 v[128:143], v[180:183], v[36:39], v[128:143]
    v_exp_f32 v115, v115
    v_exp_f32 v116, v116
    v_cvt_pk_bf16_f32 v144, v112, v113
    v_cvt_pk_bf16_f32 v145, v114, v115
    v_mfma_f32_32x32x16_bf16 v[48:63], v[184:187], v[152:155], v[48:63]
    v_exp_f32 v117, v117
    v_exp_f32 v118, v118
    v_exp_f32 v119, v119
    v_mfma_f32_32x32x16_bf16 v[48:63], v[188:191], v[156:159], v[48:63]
    s_waitcnt vmcnt(4)
    v_exp_f32 v120, v120
    v_cvt_pk_bf16_f32 v146, v116, v117
    v_cvt_pk_bf16_f32 v147, v118, v119
    v_exp_f32 v121, v121
    v_exp_f32 v122, v122
    v_exp_f32 v123, v123
    v_exp_f32 v124, v124
    v_cvt_pk_bf16_f32 v148, v120, v121
    v_cvt_pk_bf16_f32 v149, v122, v123
    v_exp_f32 v125, v125
    v_exp_f32 v126, v126
    v_exp_f32 v127, v127
    v_cvt_pk_bf16_f32 v150, v124, v125
    v_cvt_pk_bf16_f32 v151, v126, v127
    v_mfma_f32_32x32x16_bf16 v[112:127], v[192:195], v[16:19], 0
    v_exp_f32 v128, v128
    v_exp_f32 v129, v129
    v_exp_f32 v130, v130
    v_mfma_f32_32x32x16_bf16 v[112:127], v[196:199], v[20:23], v[112:127]
    v_exp_f32 v131, v131
    v_exp_f32 v132, v132
    v_cvt_pk_bf16_f32 v152, v128, v129
    v_cvt_pk_bf16_f32 v153, v130, v131
    v_mfma_f32_32x32x16_bf16 v[64:79], v[184:187], v[144:147], v[64:79]
    v_exp_f32 v133, v133
    v_exp_f32 v134, v134
    v_exp_f32 v135, v135
    v_mfma_f32_32x32x16_bf16 v[64:79], v[188:191], v[148:151], v[64:79]
    s_waitcnt vmcnt(0)
    v_exp_f32 v136, v136
    v_cvt_pk_bf16_f32 v154, v132, v133
    v_cvt_pk_bf16_f32 v155, v134, v135
    v_exp_f32 v137, v137
    v_exp_f32 v138, v138
    v_exp_f32 v139, v139
    v_exp_f32 v140, v140
    v_cvt_pk_bf16_f32 v156, v136, v137
    v_cvt_pk_bf16_f32 v157, v138, v139
    v_exp_f32 v141, v141
    v_exp_f32 v142, v142
    v_exp_f32 v143, v143
    v_cvt_pk_bf16_f32 v158, v140, v141
    v_cvt_pk_bf16_f32 v159, v142, v143
    v_mfma_f32_32x32x16_bf16 v[128:143], v[208:211], v[16:19], 0
    v_exp_f32 v112, v112
    v_exp_f32 v113, v113
    v_exp_f32 v114, v114
    v_mfma_f32_32x32x16_bf16 v[128:143], v[212:215], v[20:23], v[128:143]
    v_exp_f32 v115, v115
    v_exp_f32 v116, v116
    v_cvt_pk_bf16_f32 v144, v112, v113
    v_cvt_pk_bf16_f32 v145, v114, v115
    v_mfma_f32_32x32x16_bf16 v[80:95], v[184:187], v[152:155], v[80:95]
    v_exp_f32 v117, v117
    v_exp_f32 v118, v118
    v_exp_f32 v119, v119
    v_mfma_f32_32x32x16_bf16 v[80:95], v[188:191], v[156:159], v[80:95]
    v_exp_f32 v120, v120
    v_cvt_pk_bf16_f32 v146, v116, v117
    v_cvt_pk_bf16_f32 v147, v118, v119
    v_exp_f32 v121, v121
    v_exp_f32 v122, v122
    v_exp_f32 v123, v123
    v_exp_f32 v124, v124
    v_cvt_pk_bf16_f32 v148, v120, v121
    v_cvt_pk_bf16_f32 v149, v122, v123
    v_exp_f32 v125, v125
    v_exp_f32 v126, v126
    v_exp_f32 v127, v127
    v_cvt_pk_bf16_f32 v150, v124, v125
    v_cvt_pk_bf16_f32 v151, v126, v127
    v_mfma_f32_32x32x16_bf16 v[112:127], v[192:195], v[24:27], 0
    v_exp_f32 v128, v128
    v_exp_f32 v129, v129
    v_exp_f32 v130, v130
    v_mfma_f32_32x32x16_bf16 v[112:127], v[196:199], v[28:31], v[112:127]
    v_exp_f32 v131, v131
    v_exp_f32 v132, v132
    v_cvt_pk_bf16_f32 v152, v128, v129
    v_cvt_pk_bf16_f32 v153, v130, v131
    v_mfma_f32_32x32x16_bf16 v[48:63], v[200:203], v[144:147], v[48:63]
    v_exp_f32 v133, v133
    v_exp_f32 v134, v134
    v_exp_f32 v135, v135
    v_mfma_f32_32x32x16_bf16 v[48:63], v[204:207], v[148:151], v[48:63]
    v_exp_f32 v136, v136
    v_cvt_pk_bf16_f32 v154, v132, v133
    v_cvt_pk_bf16_f32 v155, v134, v135
    v_exp_f32 v137, v137
    v_exp_f32 v138, v138
    v_exp_f32 v139, v139
    v_exp_f32 v140, v140
    v_cvt_pk_bf16_f32 v156, v136, v137
    v_cvt_pk_bf16_f32 v157, v138, v139
    v_exp_f32 v141, v141
    v_exp_f32 v142, v142
    v_exp_f32 v143, v143
    v_cvt_pk_bf16_f32 v158, v140, v141
    v_cvt_pk_bf16_f32 v159, v142, v143
    v_mfma_f32_32x32x16_bf16 v[128:143], v[208:211], v[24:27], 0
    v_exp_f32 v112, v112
    v_exp_f32 v113, v113
    v_exp_f32 v114, v114
    v_mfma_f32_32x32x16_bf16 v[128:143], v[212:215], v[28:31], v[128:143]
    v_exp_f32 v115, v115
    v_exp_f32 v116, v116
    v_cvt_pk_bf16_f32 v144, v112, v113
    v_cvt_pk_bf16_f32 v145, v114, v115
    v_mfma_f32_32x32x16_bf16 v[48:63], v[216:219], v[152:155], v[48:63]
    v_exp_f32 v117, v117
    v_exp_f32 v118, v118
    v_exp_f32 v119, v119
    v_mfma_f32_32x32x16_bf16 v[48:63], v[220:223], v[156:159], v[48:63]
    v_exp_f32 v120, v120
    v_cvt_pk_bf16_f32 v146, v116, v117
    v_cvt_pk_bf16_f32 v147, v118, v119
    v_exp_f32 v121, v121
    v_exp_f32 v122, v122
    v_exp_f32 v123, v123
    v_exp_f32 v124, v124
    v_cvt_pk_bf16_f32 v148, v120, v121
    v_cvt_pk_bf16_f32 v149, v122, v123
    v_exp_f32 v125, v125
    v_exp_f32 v126, v126
    v_exp_f32 v127, v127
    v_cvt_pk_bf16_f32 v150, v124, v125
    v_cvt_pk_bf16_f32 v151, v126, v127
    v_mfma_f32_32x32x16_bf16 v[112:127], v[192:195], v[32:35], 0
    v_exp_f32 v128, v128
    v_exp_f32 v129, v129
    v_exp_f32 v130, v130
    v_mfma_f32_32x32x16_bf16 v[112:127], v[196:199], v[36:39], v[112:127]
    ds_write_b128 v248, v[48:51] offset:0
    v_exp_f32 v131, v131
    v_exp_f32 v132, v132
    v_cvt_pk_bf16_f32 v152, v128, v129
    v_cvt_pk_bf16_f32 v153, v130, v131
    v_mfma_f32_32x32x16_bf16 v[64:79], v[200:203], v[144:147], v[64:79]
    ds_write_b128 v248, v[52:55] offset:1024
    v_exp_f32 v133, v133
    v_exp_f32 v134, v134
    v_exp_f32 v135, v135
    v_mfma_f32_32x32x16_bf16 v[64:79], v[204:207], v[148:151], v[64:79]
    ds_write_b128 v248, v[56:59] offset:2048
    v_exp_f32 v136, v136
    v_cvt_pk_bf16_f32 v154, v132, v133
    v_cvt_pk_bf16_f32 v155, v134, v135
    v_exp_f32 v137, v137
    v_exp_f32 v138, v138
    v_exp_f32 v139, v139
    v_exp_f32 v140, v140
    v_cvt_pk_bf16_f32 v156, v136, v137
    v_cvt_pk_bf16_f32 v157, v138, v139
    v_exp_f32 v141, v141
    v_exp_f32 v142, v142
    v_exp_f32 v143, v143
    v_cvt_pk_bf16_f32 v158, v140, v141
    v_cvt_pk_bf16_f32 v159, v142, v143
    v_mfma_f32_32x32x16_bf16 v[128:143], v[208:211], v[32:35], 0
    ds_write_b128 v248, v[60:63] offset:3072
    v_exp_f32 v112, v112
    v_exp_f32 v113, v113
    v_exp_f32 v114, v114
    v_mfma_f32_32x32x16_bf16 v[128:143], v[212:215], v[36:39], v[128:143]
    v_exp_f32 v115, v115
    v_exp_f32 v116, v116
    v_cvt_pk_bf16_f32 v144, v112, v113
    v_cvt_pk_bf16_f32 v145, v114, v115
    v_mfma_f32_32x32x16_bf16 v[64:79], v[216:219], v[152:155], v[64:79]
    v_exp_f32 v117, v117
    v_exp_f32 v118, v118
    v_exp_f32 v119, v119
    v_mfma_f32_32x32x16_bf16 v[64:79], v[220:223], v[156:159], v[64:79]
    v_exp_f32 v120, v120
    v_cvt_pk_bf16_f32 v146, v116, v117
    v_cvt_pk_bf16_f32 v147, v118, v119
    v_exp_f32 v121, v121
    v_exp_f32 v122, v122
    v_exp_f32 v123, v123
    v_exp_f32 v124, v124
    v_cvt_pk_bf16_f32 v148, v120, v121
    v_cvt_pk_bf16_f32 v149, v122, v123
    v_exp_f32 v125, v125
    v_exp_f32 v126, v126
    v_exp_f32 v127, v127
    v_cvt_pk_bf16_f32 v150, v124, v125
    v_cvt_pk_bf16_f32 v151, v126, v127
    v_mfma_f32_32x32x16_bf16 v[112:127], v[160:163], v[40:43], 0
    v_exp_f32 v128, v128
    v_exp_f32 v129, v129
    v_exp_f32 v130, v130
    v_mfma_f32_32x32x16_bf16 v[112:127], v[164:167], v[44:47], v[112:127]
    ds_write_b128 v249, v[64:67] offset:0
    v_exp_f32 v131, v131
    v_exp_f32 v132, v132
    v_cvt_pk_bf16_f32 v152, v128, v129
    v_cvt_pk_bf16_f32 v153, v130, v131
    v_mfma_f32_32x32x16_bf16 v[80:95], v[200:203], v[144:147], v[80:95]
    ds_write_b128 v249, v[68:71] offset:1024
    v_exp_f32 v133, v133
    v_exp_f32 v134, v134
    v_exp_f32 v135, v135
    v_mfma_f32_32x32x16_bf16 v[80:95], v[204:207], v[148:151], v[80:95]
    ds_write_b128 v249, v[72:75] offset:2048
    v_exp_f32 v136, v136
    v_cvt_pk_bf16_f32 v154, v132, v133
    v_cvt_pk_bf16_f32 v155, v134, v135
    v_exp_f32 v137, v137
    v_exp_f32 v138, v138
    v_exp_f32 v139, v139
    v_exp_f32 v140, v140
    v_cvt_pk_bf16_f32 v156, v136, v137
    v_cvt_pk_bf16_f32 v157, v138, v139
    v_exp_f32 v141, v141
    v_exp_f32 v142, v142
    v_exp_f32 v143, v143
    v_cvt_pk_bf16_f32 v158, v140, v141
    v_cvt_pk_bf16_f32 v159, v142, v143
    v_mfma_f32_32x32x16_bf16 v[128:143], v[176:179], v[40:43], 0
    ds_write_b128 v249, v[76:79] offset:3072
    v_exp_f32 v112, v112
    v_exp_f32 v113, v113
    v_exp_f32 v114, v114
    v_mfma_f32_32x32x16_bf16 v[128:143], v[180:183], v[44:47], v[128:143]
    v_exp_f32 v115, v115
    v_exp_f32 v116, v116
    v_cvt_pk_bf16_f32 v144, v112, v113
    v_cvt_pk_bf16_f32 v145, v114, v115
    v_mfma_f32_32x32x16_bf16 v[80:95], v[216:219], v[152:155], v[80:95]
    v_exp_f32 v117, v117
    v_exp_f32 v118, v118
    v_exp_f32 v119, v119
    v_mfma_f32_32x32x16_bf16 v[80:95], v[220:223], v[156:159], v[80:95]
    v_exp_f32 v120, v120
    v_cvt_pk_bf16_f32 v146, v116, v117
    v_cvt_pk_bf16_f32 v147, v118, v119
    v_exp_f32 v121, v121
    v_exp_f32 v122, v122
    v_exp_f32 v123, v123
    v_exp_f32 v124, v124
    v_cvt_pk_bf16_f32 v148, v120, v121
    v_cvt_pk_bf16_f32 v149, v122, v123
    v_exp_f32 v125, v125
    v_exp_f32 v126, v126
    v_exp_f32 v127, v127
    v_cvt_pk_bf16_f32 v150, v124, v125
    v_cvt_pk_bf16_f32 v151, v126, v127
    v_mfma_f32_32x32x16_bf16 v[112:127], v[192:195], v[40:43], 0
    v_exp_f32 v128, v128
    v_exp_f32 v129, v129
    v_exp_f32 v130, v130
    v_mfma_f32_32x32x16_bf16 v[112:127], v[196:199], v[44:47], v[112:127]
    ds_write_b128 v250, v[80:83] offset:0
    ds_write_b128 v250, v[84:87] offset:1024
    v_exp_f32 v131, v131
    v_exp_f32 v132, v132
    v_cvt_pk_bf16_f32 v152, v128, v129
    v_cvt_pk_bf16_f32 v153, v130, v131
    v_mfma_f32_32x32x16_bf16 v[96:111], v[168:171], v[144:147], v[96:111]
    ds_write_b128 v250, v[88:91] offset:2048
    v_exp_f32 v133, v133
    v_exp_f32 v134, v134
    v_exp_f32 v135, v135
    v_mfma_f32_32x32x16_bf16 v[96:111], v[172:175], v[148:151], v[96:111]
    ds_write_b128 v250, v[92:95] offset:3072
    v_exp_f32 v136, v136
    v_cvt_pk_bf16_f32 v154, v132, v133
    v_cvt_pk_bf16_f32 v155, v134, v135
    v_exp_f32 v137, v137
    v_exp_f32 v138, v138
    v_exp_f32 v139, v139
    v_exp_f32 v140, v140
    v_cvt_pk_bf16_f32 v156, v136, v137
    v_cvt_pk_bf16_f32 v157, v138, v139
    v_exp_f32 v141, v141
    v_exp_f32 v142, v142
    v_exp_f32 v143, v143
    v_cvt_pk_bf16_f32 v158, v140, v141
    v_cvt_pk_bf16_f32 v159, v142, v143
    v_mfma_f32_32x32x16_bf16 v[128:143], v[208:211], v[40:43], 0
    s_waitcnt lgkmcnt(0)
    v_exp_f32 v112, v112
    v_exp_f32 v113, v113
    v_exp_f32 v114, v114
    v_mfma_f32_32x32x16_bf16 v[128:143], v[212:215], v[44:47], v[128:143]
    s_barrier
    v_exp_f32 v115, v115
    v_exp_f32 v116, v116
    v_cvt_pk_bf16_f32 v144, v112, v113
    v_cvt_pk_bf16_f32 v145, v114, v115
    v_mfma_f32_32x32x16_bf16 v[96:111], v[184:187], v[152:155], v[96:111]
    ds_read_b128 v[48:51], v236 offset:0
    ds_read_b128 v[64:67], v236 offset:4096
    ds_read_b128 v[80:83], v236 offset:8192
    v_exp_f32 v117, v117
    v_exp_f32 v118, v118
    v_exp_f32 v119, v119
    v_mfma_f32_32x32x16_bf16 v[96:111], v[188:191], v[156:159], v[96:111]
    ds_read_b128 v[60:63], v236 offset:3072
    ds_read_b128 v[76:79], v236 offset:7168
    ds_read_b128 v[92:95], v236 offset:11264
    v_exp_f32 v120, v120
    v_cvt_pk_bf16_f32 v146, v116, v117
    v_cvt_pk_bf16_f32 v147, v118, v119
    v_exp_f32 v121, v121
    v_exp_f32 v122, v122
    v_exp_f32 v123, v123
    v_exp_f32 v124, v124
    v_cvt_pk_bf16_f32 v148, v120, v121
    v_cvt_pk_bf16_f32 v149, v122, v123
    v_exp_f32 v125, v125
    v_exp_f32 v126, v126
    v_exp_f32 v127, v127
    v_cvt_pk_bf16_f32 v150, v124, v125
    v_cvt_pk_bf16_f32 v151, v126, v127
    v_mfma_f32_32x32x16_bf16 v[96:111], v[200:203], v[144:147], v[96:111]
    ds_read_b128 v[52:55], v236 offset:1024
    ds_read_b128 v[68:71], v236 offset:5120
    ds_read_b128 v[84:87], v236 offset:9216
    v_exp_f32 v128, v128
    v_exp_f32 v129, v129
    v_exp_f32 v130, v130
    v_exp_f32 v131, v131
    v_mfma_f32_32x32x16_bf16 v[96:111], v[204:207], v[148:151], v[96:111]
    ds_read_b128 v[56:59], v236 offset:2048
    ds_read_b128 v[72:75], v236 offset:6144
    ds_read_b128 v[88:91], v236 offset:10240
    v_exp_f32 v132, v132
    v_cvt_pk_bf16_f32 v152, v128, v129
    v_cvt_pk_bf16_f32 v153, v130, v131
    v_exp_f32 v133, v133
    v_exp_f32 v134, v134
    v_exp_f32 v135, v135
    v_exp_f32 v136, v136
    v_cvt_pk_bf16_f32 v154, v132, v133
    v_cvt_pk_bf16_f32 v155, v134, v135
    v_exp_f32 v137, v137
    v_exp_f32 v138, v138
    v_exp_f32 v139, v139
    v_mfma_f32_32x32x16_bf16 v[96:111], v[216:219], v[152:155], v[96:111]
    v_exp_f32 v140, v140
    v_cvt_pk_bf16_f32 v156, v136, v137
    v_cvt_pk_bf16_f32 v157, v138, v139
    v_exp_f32 v141, v141
    v_exp_f32 v142, v142
    v_exp_f32 v143, v143
    v_cvt_pk_bf16_f32 v158, v140, v141
    v_cvt_pk_bf16_f32 v159, v142, v143
    s_waitcnt lgkmcnt(0)
    v_add_f32 v48, v48, v64
    v_mfma_f32_32x32x16_bf16 v[96:111], v[220:223], v[156:159], v[96:111]
    v_add_f32 v49, v49, v65
    v_add_f32 v50, v50, v66
    v_add_f32 v51, v51, v67
    v_add_f32 v52, v52, v68
    v_add_f32 v53, v53, v69
    v_add_f32 v54, v54, v70
    v_add_f32 v55, v55, v71
    v_add_f32 v56, v56, v72
    v_add_f32 v57, v57, v73
    v_add_f32 v58, v58, v74
    v_add_f32 v59, v59, v75
    v_add_f32 v60, v60, v76
    v_add_f32 v61, v61, v77
    v_add_f32 v62, v62, v78
    v_add_f32 v63, v63, v79
    v_pk_add_f32 v[48:49], v[48:49], v[80:81]
    v_pk_add_f32 v[60:61], v[60:61], v[92:93]
    v_pk_add_f32 v[50:51], v[50:51], v[82:83]
    v_pk_add_f32 v[62:63], v[62:63], v[94:95]
    v_pk_add_f32 v[52:53], v[52:53], v[84:85]
    v_pk_add_f32 v[54:55], v[54:55], v[86:87]
    v_pk_add_f32 v[56:57], v[56:57], v[88:89]
    v_pk_add_f32 v[58:59], v[58:59], v[90:91]
    v_pk_add_f32 v[96:97], v[96:97], v[48:49]
    v_pk_add_f32 v[108:109], v[108:109], v[60:61]
    v_cndmask_b32 v10, v108, v96, s[18:19]
    v_cndmask_b32 v13, v108, v96, s[18:19]
    v_pk_add_f32 v[98:99], v[98:99], v[50:51]
    v_pk_add_f32 v[110:111], v[110:111], v[62:63]
    v_permlane32_swap_b32 v10, v13
    v_pk_add_f32 v[100:101], v[100:101], v[52:53]
    v_cndmask_b32 v13, v13, v10, s[18:19]
    v_pk_add_f32 v[102:103], v[102:103], v[54:55]
    v_rcp_f32 v10, v13
    v_pk_add_f32 v[104:105], v[104:105], v[56:57]
    v_pk_add_f32 v[106:107], v[106:107], v[58:59]
L_fin:
    v_pk_mul_f32 v[96:97], v[96:97], v[10:11] op_sel_hi:[1,0]
    v_pk_mul_f32 v[98:99], v[98:99], v[10:11] op_sel_hi:[1,0]
    v_pk_mul_f32 v[100:101], v[100:101], v[10:11] op_sel_hi:[1,0]
    v_pk_mul_f32 v[102:103], v[102:103], v[10:11] op_sel_hi:[1,0]
    v_cvt_pk_bf16_f32 v16, v96, v97
    v_cvt_pk_bf16_f32 v17, v98, v99
    v_cvt_pk_bf16_f32 v18, v100, v101
    v_cvt_pk_bf16_f32 v19, v102, v103
    buffer_store_dwordx4 v[16:19], v231, s[36:39], s3 offen offset:0 sc1
    v_pk_mul_f32 v[104:105], v[104:105], v[10:11] op_sel_hi:[1,0]
    v_pk_mul_f32 v[106:107], v[106:107], v[10:11] op_sel_hi:[1,0]
    v_pk_mul_f32 v[108:109], v[108:109], v[10:11] op_sel_hi:[1,0]
    v_pk_mul_f32 v[110:111], v[110:111], v[10:11] op_sel_hi:[1,0]
    v_cvt_pk_bf16_f32 v20, v104, v105
    v_cvt_pk_bf16_f32 v21, v106, v107
    v_cvt_pk_bf16_f32 v22, v108, v109
    v_cvt_pk_bf16_f32 v23, v110, v111
    buffer_store_dwordx4 v[20:23], v231, s[36:39], s3 offen offset:1024 sc1
    v_pk_mul_f32 v[8:9], v[96:97], 0 op_sel_hi:[1,0]
    v_pk_fma_f32 v[8:9], v[98:99], 0, v[8:9] op_sel_hi:[1,0,1]
    v_pk_fma_f32 v[8:9], v[100:101], 0, v[8:9] op_sel_hi:[1,0,1]
    v_pk_fma_f32 v[8:9], v[102:103], 0, v[8:9] op_sel_hi:[1,0,1]
    v_pk_fma_f32 v[8:9], v[104:105], 0, v[8:9] op_sel_hi:[1,0,1]
    v_pk_fma_f32 v[8:9], v[106:107], 0, v[8:9] op_sel_hi:[1,0,1]
    v_pk_fma_f32 v[8:9], v[108:109], 0, v[8:9] op_sel_hi:[1,0,1]
    v_pk_fma_f32 v[8:9], v[110:111], 0, v[8:9] op_sel_hi:[1,0,1]
    v_cmp_le_f32 vcc, s14, v13
    v_cmp_ge_f32 s[16:17], s15, v13
    s_and_b64 s[16:17], s[16:17], vcc
    v_cmp_o_f32 vcc, v8, v9
    s_and_b64 s[16:17], s[16:17], vcc
    s_or_b64 s[16:17], s[16:17], s[100:101]
    s_cmp_lg_u64 s[16:17], -1
    s_cbranch_scc1 L_slow
    s_mov_b64 exec, 1
    s_waitcnt vmcnt(0)
    global_atomic_add v237, v239, s[60:61] sc1
L_end:
L_quit:
    s_endpgm
L_womall:
    s_and_b32 s40, s2, 7
    s_lshl_b32 s40, s40, 2
    s_add_u32 s40, s40, s50
    s_mul_i32 s40, s40, 12544
    v_min_u32 v18, 48, v0
    v_lshl_add_u32 v18, v18, 7, s40
    v_add_u32 v19, 6272, v18
    global_load_dword v20, v18, s[100:101]
    global_load_dword v21, v19, s[100:101]
    s_waitcnt vmcnt(0)
    s_branch L_womall_back
L_hs:
    s_mov_b32 s42, 0
L_hs1:
    s_sleep 8
    global_load_dword v6, v7, s[98:99] sc1
    s_add_u32 s42, s42, 1
    s_waitcnt vmcnt(0)
    v_cmp_eq_u32 vcc, 0, v6
    s_cbranch_vccz L_hs_ok
    s_cmp_lt_u32 s42, 65536
    s_cbranch_scc1 L_hs1
    s_branch L_hs_ok
L_uc_1:
    s_waitcnt vmcnt(0)
    v_readfirstlane_b32 s40, v14
    s_cmp_lg_u32 s40, 22
    s_cbranch_scc1 L_ua_1
    s_add_u32 m0, s17, 74624
    s_mov_b32 s11, 1
    buffer_load_dwordx4 v19, s[36:39], s14 offen sc1 lds
    s_add_u32 m0, m0, 1024
    s_nop 0
    buffer_load_dwordx4 v19, s[36:39], s15 offen sc1 lds
    s_branch L_ub_1
L_ua_1:
    s_mov_b64 exec, 1
    global_atomic_add v14, v20, v7, s[60:61] sc0 sc1
    s_mov_b64 exec, -1
    s_branch L_ub_1
L_uc_2:
    s_waitcnt vmcnt(0)
    v_readfirstlane_b32 s40, v14
    s_cmp_lg_u32 s40, 22
    s_cbranch_scc1 L_ua_2
    s_add_u32 m0, s17, 74624
    s_mov_b32 s11, 1
    buffer_load_dwordx4 v19, s[36:39], s14 offen sc1 lds
    s_add_u32 m0, m0, 1024
    s_nop 0
    buffer_load_dwordx4 v19, s[36:39], s15 offen sc1 lds
    s_mov_b32 m0, s18
    s_branch L_ub_2
L_ua_2:
    s_mov_b64 exec, 1
    global_atomic_add v14, v20, v7, s[60:61] sc0 sc1
    s_mov_b64 exec, -1
    s_branch L_ub_2
L_give_u:
    s_waitcnt vmcnt(0)
    s_branch L_ok_u
L_u_late:
    s_waitcnt vmcnt(0)
    v_readfirstlane_b32 s40, v14
    s_cmp_eq_u32 s40, 22
    s_cbranch_scc1 L_ok_u
    s_mov_b64 exec, 1
    v_mov_b32 v15, 0
    s_mov_b32 s40, 0
L_poll_u:
L_poll1_u:
    global_atomic_add v14, v20, v15, s[60:61] sc0 sc1
    s_add_u32 s40, s40, 1
    s_cmp_ge_u32 s40, 65536
    s_cbranch_scc1 L_give_u
    s_waitcnt vmcnt(0)
    v_cmp_ne_u32 vcc, 22, v14
    s_cbranch_vccnz L_poll_u
L_ok_u:
    s_mov_b64 exec, -1
    s_add_u32 m0, s17, 74624
    s_mov_b32 s11, 1
    buffer_load_dwordx4 v19, s[36:39], s14 offen sc1 lds
    s_add_u32 m0, m0, 1024
    s_nop 0
    buffer_load_dwordx4 v19, s[36:39], s15 offen sc1 lds
    s_branch L_u_done
L_give_b:
    s_waitcnt vmcnt(0)
    s_branch L_ok_b
L_give_o:
    s_waitcnt vmcnt(0)
    s_branch L_ok_o
L_kscale:
    v_mul_f32 v160, s47, v160
    v_mul_f32 v161, s47, v161
    v_mul_f32 v162, s47, v162
    v_mul_f32 v163, s47, v163
    v_mul_f32 v164, s47, v164
    v_mul_f32 v165, s47, v165
    v_mul_f32 v166, s47, v166
    v_mul_f32 v167, s47, v167
    v_mul_f32 v168, s47, v168
    v_mul_f32 v169, s47, v169
    v_mul_f32 v170, s47, v170
    v_mul_f32 v171, s47, v171
    v_mul_f32 v172, s47, v172
    v_mul_f32 v173, s47, v173
    v_mul_f32 v174, s47, v174
    v_mul_f32 v175, s47, v175
    s_branch L_kscaled
L_give_a:
    s_waitcnt vmcnt(0)
    s_branch L_ok_a
L_give_s:
    s_waitcnt vmcnt(0)
    s_branch L_ok_s
L_late:
    s_mov_b64 exec, 1
    v_mov_b32 v15, 0
    s_mov_b32 s40, 0
L_poll_s:
L_poll1_s:
    global_atomic_add v14, v228, v15, s[60:61] sc0 sc1
    s_add_u32 s40, s40, 1
    s_cmp_ge_u32 s40, 65536
    s_cbranch_scc1 L_give_s
    s_waitcnt vmcnt(0)
    v_cmp_ne_u32 vcc, s9, v14
    s_cbranch_vccnz L_poll_s
L_ok_s:
    s_mov_b64 exec, -1
    s_branch L_late_ok
L_slow:
    s_mov_b64 s[100:101], -1
    s_waitcnt vmcnt(0)
    v_mov_b32 v208, 0xff800000
    s_mov_b64 s[96:97], s[22:23]
    s_mov_b32 s16, 0
L_s1:
    global_load_dwordx4 v[160:163], v224, s[96:97] sc1
    global_load_dwordx4 v[164:167], v224, s[96:97] offset:1024 sc1
    s_add_u32 s96, s96, 28672
    s_addc_u32 s97, s97, 0
    s_waitcnt vmcnt(0)
    v_mfma_f32_32x32x16_bf16 v[112:127], v[160:163], v[40:43], 0
    v_mfma_f32_32x32x16_bf16 v[112:127], v[164:167], v[44:47], v[112:127]
    s_nop 15
    v_max3_f32 v208, v208, v112, v113
    v_max3_f32 v208, v208, v114, v115
    v_max3_f32 v208, v208, v116, v117
    v_max3_f32 v208, v208, v118, v119
    v_max3_f32 v208, v208, v120, v121
    v_max3_f32 v208, v208, v122, v123
    v_max3_f32 v208, v208, v124, v125
    v_max3_f32 v208, v208, v126, v127
    s_add_u32 s16, s16, 1
    s_cmp_lt_u32 s16, 64
    s_cbranch_scc1 L_s1
    v_mov_b32 v209, v208
    s_nop 1
    v_permlane32_swap_b32 v208, v209
    s_nop 1
    v_max_f32 v208, v208, v209
    v_mov_b32 v96, 0
    v_mov_b32 v97, 0
    v_mov_b32 v98, 0
    v_mov_b32 v99, 0
    v_mov_b32 v100, 0
    v_mov_b32 v101, 0
    v_mov_b32 v102, 0
    v_mov_b32 v103, 0
    v_mov_b32 v104, 0
    v_mov_b32 v105, 0
    v_mov_b32 v106, 0
    v_mov_b32 v107, 0
    v_mov_b32 v108, 0
    v_mov_b32 v109, 0
    v_mov_b32 v110, 0
    v_mov_b32 v111, 0
    s_mov_b64 s[96:97], s[22:23]
    s_mov_b32 s16, 0
L_s2:
    global_load_dwordx4 v[160:163], v224, s[96:97] sc1
    global_load_dwordx4 v[164:167], v224, s[96:97] offset:1024 sc1
    global_load_dwordx4 v[168:171], v225, s[96:97] sc1
    global_load_dwordx4 v[172:175], v226, s[96:97] sc1
    s_add_u32 s96, s96, 28672
    s_addc_u32 s97, s97, 0
    s_waitcnt vmcnt(0)
    v_mfma_f32_32x32x16_bf16 v[112:127], v[160:163], v[40:43], 0
    v_mfma_f32_32x32x16_bf16 v[112:127], v[164:167], v[44:47], v[112:127]
    s_nop 15
    v_sub_f32 v112, v112, v208
    v_sub_f32 v113, v113, v208
    v_sub_f32 v114, v114, v208
    v_sub_f32 v115, v115, v208
    v_sub_f32 v116, v116, v208
    v_sub_f32 v117, v117, v208
    v_sub_f32 v118, v118, v208
    v_sub_f32 v119, v119, v208
    v_sub_f32 v120, v120, v208
    v_sub_f32 v121, v121, v208
    v_sub_f32 v122, v122, v208
    v_sub_f32 v123, v123, v208
    v_sub_f32 v124, v124, v208
    v_sub_f32 v125, v125, v208
    v_sub_f32 v126, v126, v208
    v_sub_f32 v127, v127, v208
    v_exp_f32 v112, v112
    v_exp_f32 v113, v113
    v_exp_f32 v114, v114
    v_exp_f32 v115, v115
    v_exp_f32 v116, v116
    v_exp_f32 v117, v117
    v_exp_f32 v118, v118
    v_exp_f32 v119, v119
    v_exp_f32 v120, v120
    v_exp_f32 v121, v121
    v_exp_f32 v122, v122
    v_exp_f32 v123, v123
    v_exp_f32 v124, v124
    v_exp_f32 v125, v125
    v_exp_f32 v126, v126
    v_exp_f32 v127, v127
    s_nop 0
    v_cvt_pk_bf16_f32 v144, v112, v113
    v_cvt_pk_bf16_f32 v145, v114, v115
    v_cvt_pk_bf16_f32 v146, v116, v117
    v_cvt_pk_bf16_f32 v147, v118, v119
    v_cvt_pk_bf16_f32 v148, v120, v121
    v_cvt_pk_bf16_f32 v149, v122, v123
    v_cvt_pk_bf16_f32 v150, v124, v125
    v_cvt_pk_bf16_f32 v151, v126, v127
    s_nop 1
    v_mfma_f32_32x32x16_bf16 v[96:111], v[168:171], v[144:147], v[96:111]
    v_mfma_f32_32x32x16_bf16 v[96:111], v[172:175], v[148:151], v[96:111]
    s_add_u32 s16, s16, 1
    s_cmp_lt_u32 s16, 64
    s_cbranch_scc1 L_s2
    s_nop 15
    v_cndmask_b32 v10, v108, v96, s[18:19]
    v_cndmask_b32 v13, v108, v96, s[18:19]
    s_nop 0
    s_nop 0
    v_permlane32_swap_b32 v10, v13
    s_nop 0
    v_cndmask_b32 v13, v13, v10, s[18:19]
    s_nop 0
    v_rcp_f32 v10, v13
    s_nop 0
    s_nop 0
    s_branch L_fin
.section .rodata,"a"
.p2align 6
.amdhsa_kernel gated_mix__mha_block__ssm_conv_s4d__prompt_kernel
  .amdhsa_next_free_vgpr 256
  .amdhsa_next_free_sgpr 102
  .amdhsa_accum_offset 256
  .amdhsa_group_segment_fixed_size 0
  .amdhsa_kernarg_size 112
  .amdhsa_user_sgpr_count 2
  .amdhsa_user_sgpr_kernarg_segment_ptr 1
  .amdhsa_system_sgpr_workgroup_id_x 1
.end_amdhsa_kernel
```
